```python
import torch

def _softmax(x, axis=-1):
    return torch.softmax(x, dim=axis)

def _gelu(x):
    return torch.nn.functional.gelu(x, approximate='tanh')

def _silu(x):
    return torch.nn.functional.silu(x)

def _sigmoid(x):
    return torch.sigmoid(x)

def _layernorm(x, axis=-1, eps=1e-05):
    m = x.mean(dim=axis, keepdim=True)
    v = x.var(dim=axis, keepdim=True, unbiased=False)
    return (x - m) / torch.sqrt(v + eps)

def _scatter_add(tgt, idx, src, axis=0):
    return tgt.clone().index_add_(axis, idx, src)

def _segment_sum(src, seg, n):
    out = torch.zeros((n,) + src.shape[1:], dtype=src.dtype)
    return out.index_add_(0, seg, src)

def _pad(x, pw):
    flat = tuple((v for pair in reversed(pw) for v in pair))
    return torch.nn.functional.pad(x, flat)
kernel_name = 'adaLN_cond__ssm_conv_s4d__dense_activation_silu__prompt'

def setup_inputs():

    _w = lambda a: (lambda t: t.to(torch.bfloat16) if t.is_floating_point() else t)(torch.as_tensor(a))

    def _A_setup():
        Bsz, L, D, N = (1, 2048, 640, 128)
        return {'u': _w((lambda *s: torch.randn(*s, dtype=torch.bfloat16) * 0.05)(Bsz, L, D)), 'log_A_real': _w((lambda *s: torch.randn(*s, dtype=torch.bfloat16) * 3.2)(D, N) * 0.5), 'A_imag': _w((lambda *s: torch.randn(*s, dtype=torch.bfloat16) * 0.05)(D, N) * 3.14), 'C_real': _w((lambda *s: torch.randn(*s, dtype=torch.bfloat16) * 0.1)(D, N) / N ** 0.5), 'C_imag': _w((lambda *s: torch.randn(*s, dtype=torch.bfloat16) * 0.2)(D, N) / N ** 0.5), 'log_dt': _w((lambda *s: torch.randn(*s, dtype=torch.bfloat16) * 0.05)(D) * 0.5 - 4.0), 'D_skip': _w((lambda *s: torch.randn(*s, dtype=torch.bfloat16) * 0.05)(D))}
    _A_in = _A_setup()

    def _B_setup():
        B, S, D, F = (1, 2048, 640, 1728)
        return {'x': _w((lambda *s: torch.randn(*s, dtype=torch.bfloat16) * 0.05)(B, S, D)), 'w1': _w((lambda *s: torch.randn(*s, dtype=torch.bfloat16) * 3.2)(D, F) * D ** (-0.5)), 'w2': _w((lambda *s: torch.randn(*s, dtype=torch.bfloat16) * 0.2)(F, D) * F ** (-0.5))}
    _B_in = _B_setup()
    return {'A_u': _A_in['u'], 'A_log_A_real': _A_in['log_A_real'], 'A_A_imag': _A_in['A_imag'], 'A_C_real': _A_in['C_real'], 'A_C_imag': _A_in['C_imag'], 'A_log_dt': _A_in['log_dt'], 'A_D_skip': _A_in['D_skip'], 'B_x': _B_in['x'], 'B_w1': _B_in['w1'], 'B_w2': _B_in['w2'], 'c': _w((lambda *s: torch.randn(*s, dtype=torch.bfloat16) * 0.2)(1, 640) * 8.0), 'w_mod': _w((lambda *s: torch.randn(*s, dtype=torch.bfloat16) * 0.2)(640, 6 * 640) * 640 ** (-0.5) * 8.0)}

def reference(A_u, A_log_A_real, A_A_imag, A_C_real, A_C_imag, A_log_dt, A_D_skip, B_x, B_w1, B_w2, c, w_mod):

    def _A_ref(u, log_A_real, A_imag, C_real, C_imag, log_dt, D_skip):
        L = u.shape[1]
        dt = torch.exp(log_dt)
        A = -torch.exp(log_A_real) + 1j * A_imag
        C = (C_real + 1j * C_imag) * dt[:, None]
        pos = (lambda x, dt: x.to(dt))(torch.arange(L), log_dt.dtype)
        P = torch.exp((A * dt[:, None])[:, :, None] * pos[None, None, :])
        K = 2.0 * torch.einsum('dn,dnl->dl', C, P).real
        L2 = 2 * L
        u_t = (lambda x, *d: x.permute(*d))(u, 0, 2, 1)
        Kf = (lambda x, *a, **k: torch.fft.rfft(x.float(), *a, **k))(K, L2)
        Uf = (lambda x, *a, **k: torch.fft.rfft(x.float(), *a, **k))(u_t, L2)
        y = (lambda x, *a, **k: torch.fft.irfft(x, *a, **k).to(torch.bfloat16))(Uf * Kf[None, :, :], L2)[:, :, :L]
        y = (lambda x, *d: x.permute(*d))(y, 0, 2, 1)
        return y + u * D_skip[None, None, :]

    def _B_ref(x, w1, w2):
        h = torch.einsum('bsd,df->bsf', x, w1)
        h = _silu(h)
        out = torch.einsum('bsf,fd->bsd', h, w2)
        return out
    x = A_u
    mod = (_silu(c) @ w_mod).reshape(c.shape[0], 6, 1, -1)
    sa, ca, ga, sb, cb, gb = (mod[:, 0].clone(), mod[:, 1].clone(), mod[:, 2].clone(), mod[:, 3].clone(), mod[:, 4].clone(), mod[:, 5].clone())
    h = _layernorm(x, axis=-1) * (1 + ca) + sa
    x = x + ga * _A_ref(h, A_log_A_real, A_A_imag, A_C_real, A_C_imag, A_log_dt, A_D_skip)
    h = _layernorm(x, axis=-1) * (1 + cb) + sb
    x = x + gb * _B_ref(h, B_w1, B_w2)
    return x
```

```asm
; @launch grid=(256,1,1) block=(256,1,1) lds=163840
.amdgcn_target "amdgcn-amd-amdhsa--gfx950"
.text
.p2align 8
.globl adaLN_cond__ssm_conv_s4d__dense_activation_silu__prompt_kernel
.type adaLN_cond__ssm_conv_s4d__dense_activation_silu__prompt_kernel,@function
adaLN_cond__ssm_conv_s4d__dense_activation_silu__prompt_kernel:
    s_load_dwordx16 s[4:19], s[0:1], 0
    s_load_dwordx8 s[20:27], s[0:1], 64
    s_load_dwordx4 s[28:31], s[0:1], 96
    s_load_dwordx2 s[32:33], s[0:1], 112
    s_cmp_ge_u32 s2, 256
    s_cbranch_scc1 F_end
    v_and_b32 v1, 63, v0
    v_lshrrev_b32 v2, 6, v0
    s_and_b32 s61, s2, 7
    s_lshr_b32 s62, s2, 3
    v_readfirstlane_b32 s60, v2
    s_getpc_b64 s[98:99]
F_pc0:
    s_lshl_b32 s97, s62, 11
    v_lshlrev_b32 v94, 3, v0
    v_add_u32 v94, s97, v94
    v_min_u32 v94, F_end-F_pc0-8, v94
    global_load_dwordx2 v[184:185], v94, s[98:99]
    v_lshlrev_b32 v94, 4, v0
    global_load_dwordx4 v[188:191], v94, s[98:99]
    s_lshr_b32 s63, s2, 4
    s_bfe_u32 s64, s2, 0x20002
    s_and_b32 s65, s2, 3
    s_lshl_b32 s66, s63, 7
    s_lshl3_add_u32 s66, s64, s66
    s_add_u32 s66, s66, s65
    s_mul_i32 s66, s66, 1280
    v_and_b32 v3, 7, v0
    v_lshrrev_b32 v4, 3, v0
    v_lshrrev_b32 v5, 1, v3
    v_and_b32 v8, 1, v0
    v_lshl_add_u32 v9, v5, 3, v8
    v_mul_u32_u24 v5, 5120, v9
    v_lshl_add_u32 v5, v4, 3, v5
    s_lshr_b32 s67, s2, 2
    s_min_u32 s67, s67, 59
    s_mul_i32 s68, s65, 160
    s_mul_i32 s69, s60, 40
    s_add_u32 s68, s68, s69
    s_mul_i32 s69, s68, 7680
    s_lshl_b32 s70, s67, 7
    s_add_u32 s69, s69, s70
    s_lshl_b32 s68, s68, 1
    v_lshrrev_b32 v7, 3, v1
    v_mul_u32_u24 v91, 7680, v7
    v_lshl_add_u32 v91, v3, 4, v91
    v_min_u32 v90, 4, v3
    v_lshl_add_u32 v90, v90, 3, v7
    v_lshlrev_b32 v90, 1, v90
    s_waitcnt lgkmcnt(0)
    s_mov_b32 s36, s32
    s_mov_b32 s37, s33
    s_mov_b32 s38, 0x1700000
    s_mov_b32 s39, 0x20000
    s_mov_b32 s40, s4
    s_mov_b32 s41, s5
    s_mov_b32 s42, 2621440
    s_mov_b32 s43, 0x20000
    buffer_load_dwordx2 v[10:11], v5, s[40:43], s66 offen offset:0
    buffer_load_dwordx2 v[14:15], v5, s[40:43], s66 offen offset:256
    buffer_load_dwordx2 v[18:19], v5, s[40:43], s66 offen offset:512
    buffer_load_dwordx2 v[22:23], v5, s[40:43], s66 offen offset:768
    buffer_load_dwordx2 v[26:27], v5, s[40:43], s66 offen offset:1024
    s_mov_b32 s44, s26
    s_mov_b32 s45, s27
    s_mov_b32 s46, 4915200
    s_mov_b32 s47, 0x20000
    s_mov_b32 s48, s24
    s_mov_b32 s49, s25
    s_mov_b32 s50, 1280
    s_mov_b32 s51, 0x20000
    buffer_load_ushort v68, v90, s[48:51], s68 offen
    buffer_load_dwordx4 v[48:51], v91, s[44:47], s69 offen
    s_add_u32 s69, s69, 61440
    buffer_load_dwordx4 v[52:55], v91, s[44:47], s69 offen
    s_add_u32 s69, s69, 61440
    buffer_load_dwordx4 v[56:59], v91, s[44:47], s69 offen
    s_add_u32 s69, s69, 61440
    buffer_load_dwordx4 v[60:63], v91, s[44:47], s69 offen
    s_add_u32 s69, s69, 61440
    buffer_load_dwordx4 v[64:67], v91, s[44:47], s69 offen
    s_load_dword s35, s[32:33], 0
    s_lshl_b32 s69, s65, 4
    s_add_u32 s63, s63, s69
    s_lshl_b32 s69, s63, 7
    s_lshl3_add_u32 s69, s64, s69
    s_add_u32 s69, s69, 0x58000
    s_lshl_b32 s64, s64, 13
    s_lshl_b32 s63, s63, 7
    s_add_u32 s63, s63, s64
    s_add_u32 s63, s63, 0x100000
    v_lshlrev_b32 v6, 14, v4
    v_lshl_add_u32 v6, v3, 3, v6
    v_and_b32 v86, 1, v4
    v_mul_u32_u24 v86, 16320, v86
    v_sub_u32 v6, v6, v86
    v_lshlrev_b32 v9, 2, v9
    s_cmp_eq_u32 s60, 0
    s_cselect_b32 s69, s69, 0x7f000000
    s_mul_i32 s68, s65, 15360
    s_lshl_b32 s70, s67, 8
    s_add_u32 s68, s68, s70
    s_add_u32 s68, s68, 0x40000
    s_cmp_lt_u32 s2, 240
    s_cselect_b32 s68, s68, 0x7f000000
    s_cmp_eq_u32 s60, 0
    s_cselect_b32 s68, s68, 0x7f000000
    s_lshl_b32 s70, s60, 2
    s_add_u32 s70, s70, 160256
    v_bfe_u32 v86, v1, 4, 1
    v_lshl_add_u32 v86, v3, 1, v86
    v_lshlrev_b32 v86, 4, v86
    v_add_u32 v86, s70, v86
    v_lshl_add_u32 v87, v3, 3, v7
    v_lshlrev_b32 v87, 4, v87
    v_add_u32 v87, s70, v87
    v_lshlrev_b32 v88, 5, v3
    v_add_u32 v88, 160256, v88
    v_lshlrev_b32 v89, 4, v1
    v_add_u32 v89, 160256, v89
    v_lshlrev_b32 v90, 2, v1
    s_mov_b32 s64, 0x3f803f80
    v_mov_b32 v82, 0
    v_mov_b32 v83, 0
    v_mov_b32 v84, 0
    v_mov_b32 v85, 0
    v_mov_b32 v74, 0
    v_mov_b32 v75, 0
    v_mov_b32 v76, 0
    v_mov_b32 v77, 0
    v_mov_b32 v78, 0
    v_mov_b32 v79, 0
    v_mov_b32 v80, 0
    v_mov_b32 v81, 0
    s_mul_i32 s71, s61, 20
    s_min_u32 s72, s62, 19
    s_add_u32 s71, s71, s72
    s_mov_b32 s40, s6
    s_mov_b32 s41, s7
    s_mov_b32 s42, 163840
    s_mov_b32 s43, 0x20000
    s_mov_b32 s44, s8
    s_mov_b32 s45, s9
    s_mov_b32 s46, 163840
    s_mov_b32 s47, 0x20000
    s_mov_b32 s48, s10
    s_mov_b32 s49, s11
    s_mov_b32 s50, 163840
    s_mov_b32 s51, 0x20000
    s_mov_b32 s52, s12
    s_mov_b32 s53, s13
    s_mov_b32 s54, 163840
    s_mov_b32 s55, 0x20000
    s_mov_b32 s56, s14
    s_mov_b32 s57, s15
    s_mov_b32 s58, 1280
    s_mov_b32 s59, 0x20000
    s_mov_b32 s80, s16
    s_mov_b32 s81, s17
    s_mov_b32 s82, 1280
    s_mov_b32 s83, 0x20000
    s_lshl_b32 s72, s71, 2
    s_add_u32 s72, s72, s60
    s_lshl_b32 s73, s72, 8
    s_lshl_b32 s72, s72, 1
    v_lshlrev_b32 v100, 2, v1
    v_mov_b32 v101, 0
    buffer_load_ushort v106, v101, s[56:59], s72 offen
    buffer_load_dword v102, v100, s[40:43], s73 offen
    buffer_load_dword v103, v100, s[44:47], s73 offen
    buffer_load_dword v104, v100, s[48:51], s73 offen
    buffer_load_dword v105, v100, s[52:55], s73 offen
    v_and_b32 v101, 3, v1
    v_lshlrev_b32 v101, 1, v101
    s_lshl_b32 s72, s71, 3
    buffer_load_ushort v240, v101, s[80:83], s72 offen
    v_lshrrev_b32 v28, 5, v1
    v_bfe_u32 v29, v1, 4, 1
    v_bfe_u32 v30, v1, 2, 2
    v_and_b32 v31, 1, v1
    v_bfe_u32 v32, v1, 1, 1
    v_and_b32 v33, 7, v1
    v_bfe_u32 v34, v1, 3, 1
    s_mul_i32 s76, s60, 33792
    s_add_u32 s77, s76, 9184
    v_lshlrev_b32 v35, 5, v31
    v_lshl_add_u32 v35, v29, 4, v35
    v_lshl_add_u32 v35, v32, 3, v35
    v_lshlrev_b32 v36, 6, v28
    v_lshl_add_u32 v36, v30, 3, v36
    v_sub_u32 v35, v35, v36
    v_add_u32 v218, s77, v35
    v_lshl_add_u32 v35, v34, 1, v29
    v_mul_u32_u24 v35, 1152, v35
    v_add_u32 v36, v33, v28
    v_lshl_add_u32 v35, v36, 4, v35
    v_add_u32 v219, s76, v35
    v_lshlrev_b32 v243, 4, v1
    v_mul_u32_u24 v217, 37, v1
    v_lshrrev_b32 v217, 8, v217
    v_mul_u32_u24 v217, 1040, v217
    v_add3_u32 v217, v217, v243, s76
    v_lshrrev_b32 v35, 3, v1
    v_lshlrev_b32 v35, 1, v35
    v_lshl_add_u32 v35, v33, 4, v35
    s_add_u32 s76, s76, 112
    v_add_u32 v220, s76, v35
    v_add_u32 v35, 7, v1
    v_and_b32 v35, 7, v35
    v_lshl_add_u32 v35, v34, 3, v35
    v_add_u32 v35, 48, v35
    v_subrev_u32 v36, 16, v1
    v_cmp_gt_u32 vcc, 16, v1
    s_nop 1
    v_cndmask_b32 v35, v36, v35, vcc
    v_lshlrev_b32 v222, 2, v35
    v_or_b32 v223, 32, v222
    v_mov_b32 v225, 0
    v_lshrrev_b32 v35, 4, v1
    v_cmp_eq_u32 vcc, 1, v35
    s_nop 1
    v_cndmask_b32 v224, 0, 1.0, vcc
    v_and_b32 v36, 3, v1
    v_mul_u32_u24 v35, 2560, v35
    v_mul_u32_u24 v30, 15360, v30
    v_lshl_add_u32 v35, v36, 2, v35
    v_add_u32 v227, v35, v30
    s_mul_i32 s76, s60, 1152
    v_add_u32 v241, s76, v243
    v_add_u32 v242, 67584, v241
    v_lshlrev_b32 v35, 3, v1
    s_lshl_b32 s76, s60, 12
    s_add_u32 s76, s76, 143872
    v_add_u32 v221, s76, v35
    s_lshl_b32 s76, s60, 9
    s_add_u32 s76, s76, 143872
    v_add_u32 v244, s76, v35
    v_lshlrev_b32 v226, 4, v0
    v_lshlrev_b32 v216, 5, v0
    s_mov_b32 s86, 0x05040100
    s_mov_b32 s87, 0x07060302
    s_add_u32 s72, s60, 32
    s_mov_b32 s73, 0x58000
    s_lshl_b32 s76, s71, 14
    s_add_u32 s77, s76, 0x100000
    s_add_u32 s98, s76, 0x600000
    s_lshl_b32 s76, s60, 11
    s_add_u32 s48, s98, s76
    s_add_u32 s49, s48, 8192
    s_cmp_lt_u32 s60, 3
    s_cselect_b32 s50, s49, 0x7f000000
    s_lshl_b32 s85, s71, 4
    s_add_u32 s85, s85, 0x40000
    v_mov_b32 v228, 0
    v_mov_b32 v236, -1
    v_mov_b32 v229, 0
    v_mov_b32 v237, -1
    v_mov_b32 v230, 0
    v_mov_b32 v238, -1
    v_mov_b32 v231, 0
    v_mov_b32 v239, -1
    v_and_b32 v248, -4, v0
    v_add_u32 v248, v248, v0
    v_lshlrev_b32 v248, 4, v248
    s_and_b32 s76, s71, 1
    s_mul_i32 s76, s76, 16320
    s_sub_u32 s77, s77, s76
    v_mul_u32_u24 v246, 2816, v1
    v_mov_b32 v35, 0x7f000000
    v_cmp_gt_u32 vcc, 8, v1
    s_nop 1
    v_cndmask_b32 v246, v35, v246, vcc
    v_lshlrev_b32 v247, 3, v1
    v_cmp_gt_u32 vcc, 40, v1
    s_nop 1
    v_cndmask_b32 v247, v35, v247, vcc
    s_lshl2_add_u32 s51, s71, s60
    s_lshl_b32 s51, s51, 2
    s_add_u32 s51, s51, 0x34000
    s_lshr_b32 s92, s61, 1
    s_lshl_b32 s92, s92, 2
    s_lshr_b32 s65, s62, 3
    s_add_u32 s92, s92, s65
    s_and_b32 s93, s61, 1
    s_lshl_b32 s93, s93, 3
    s_and_b32 s65, s62, 7
    s_add_u32 s93, s93, s65
    s_lshr_b32 s94, s61, 1
    s_lshl_b32 s94, s94, 3
    s_lshr_b32 s65, s62, 2
    s_add_u32 s94, s94, s65
    s_and_b32 s95, s61, 1
    s_lshl_b32 s95, s95, 2
    s_and_b32 s65, s62, 3
    s_add_u32 s95, s95, s65
    s_mov_b32 s88, s60
    s_lshl_b32 s89, s61, 9
    s_add_u32 s89, s89, 0x32000
    s_lshr_b32 s74, s2, 3
    s_xor_b32 s74, s74, s2
    s_and_b32 s74, s74, 31
    s_mul_i32 s74, s74, 1536
    s_add_u32 s74, s74, 0x19000
    s_waitcnt vmcnt(16)
    v_dot2c_f32_bf16 v82, s64, v10
    v_dot2c_f32_bf16 v84, v10, v10
    v_dot2c_f32_bf16 v83, s64, v11
    v_dot2c_f32_bf16 v85, v11, v11
    s_waitcnt vmcnt(15)
    v_dot2c_f32_bf16 v82, s64, v14
    v_dot2c_f32_bf16 v84, v14, v14
    v_dot2c_f32_bf16 v83, s64, v15
    v_dot2c_f32_bf16 v85, v15, v15
    s_waitcnt vmcnt(14)
    v_dot2c_f32_bf16 v82, s64, v18
    v_dot2c_f32_bf16 v84, v18, v18
    v_dot2c_f32_bf16 v83, s64, v19
    v_dot2c_f32_bf16 v85, v19, v19
    s_waitcnt vmcnt(13)
    v_dot2c_f32_bf16 v82, s64, v22
    v_dot2c_f32_bf16 v84, v22, v22
    v_dot2c_f32_bf16 v83, s64, v23
    v_dot2c_f32_bf16 v85, v23, v23
    s_waitcnt vmcnt(12)
    v_dot2c_f32_bf16 v82, s64, v26
    v_dot2c_f32_bf16 v84, v26, v26
    v_dot2c_f32_bf16 v83, s64, v27
    v_dot2c_f32_bf16 v85, v27, v27
    s_nop 1
    v_add_f32 v82, v82, v83
    v_add_f32 v84, v84, v85
    s_nop 0
    v_add_f32_dpp v82, v82, v82 row_ror:8 row_mask:0xf bank_mask:0xf
    v_add_f32_dpp v84, v84, v84 row_ror:8 row_mask:0xf bank_mask:0xf
    s_nop 1
    v_permlane16_swap_b32 v82, v84
    v_add_f32 v82, v82, v84
    v_mov_b32 v84, v82
    s_nop 1
    v_permlane32_swap_b32 v82, v84
    v_add_f32 v82, v82, v84
    ds_write_b32 v86, v82
    buffer_store_dwordx2 v[10:11], v6, s[36:39], s63 offen sc1
    s_add_u32 s63, s63, 0x80000
    buffer_store_dwordx2 v[14:15], v6, s[36:39], s63 offen sc1
    s_add_u32 s63, s63, 0x80000
    buffer_store_dwordx2 v[18:19], v6, s[36:39], s63 offen sc1
    s_add_u32 s63, s63, 0x80000
    buffer_store_dwordx2 v[22:23], v6, s[36:39], s63 offen sc1
    s_add_u32 s63, s63, 0x80000
    buffer_store_dwordx2 v[26:27], v6, s[36:39], s63 offen sc1
    s_waitcnt vmcnt(16)
    v_lshlrev_b32 v68, 16, v68
    v_mul_f32 v69, 0xbfb8aa3b, v68
    v_exp_f32 v69, v69
    s_nop 0
    v_add_f32 v69, 1.0, v69
    v_rcp_f32 v69, v69
    s_nop 0
    v_mul_f32 v68, v68, v69
    v_cvt_pk_bf16_f32 v68, v68, v68
    ds_swizzle_b32 v69, v68 offset:24
    ds_swizzle_b32 v70, v68 offset:56
    ds_swizzle_b32 v71, v68 offset:88
    ds_swizzle_b32 v72, v68 offset:120
    ds_swizzle_b32 v73, v68 offset:152
    s_waitcnt lgkmcnt(0)
    v_and_b32 v92, 0xffff, v69
    v_and_b32 v93, 0xffff0000, v69
    s_waitcnt vmcnt(15)
    v_dot2c_f32_bf16 v74, v92, v48
    v_dot2c_f32_bf16 v75, v93, v48
    v_dot2c_f32_bf16 v76, v92, v49
    v_dot2c_f32_bf16 v77, v93, v49
    v_dot2c_f32_bf16 v78, v92, v50
    v_dot2c_f32_bf16 v79, v93, v50
    v_dot2c_f32_bf16 v80, v92, v51
    v_dot2c_f32_bf16 v81, v93, v51
    v_and_b32 v92, 0xffff, v70
    v_and_b32 v93, 0xffff0000, v70
    s_waitcnt vmcnt(14)
    v_dot2c_f32_bf16 v74, v92, v52
    v_dot2c_f32_bf16 v75, v93, v52
    v_dot2c_f32_bf16 v76, v92, v53
    v_dot2c_f32_bf16 v77, v93, v53
    v_dot2c_f32_bf16 v78, v92, v54
    v_dot2c_f32_bf16 v79, v93, v54
    v_dot2c_f32_bf16 v80, v92, v55
    v_dot2c_f32_bf16 v81, v93, v55
    v_and_b32 v92, 0xffff, v71
    v_and_b32 v93, 0xffff0000, v71
    s_waitcnt vmcnt(13)
    v_dot2c_f32_bf16 v74, v92, v56
    v_dot2c_f32_bf16 v75, v93, v56
    v_dot2c_f32_bf16 v76, v92, v57
    v_dot2c_f32_bf16 v77, v93, v57
    v_dot2c_f32_bf16 v78, v92, v58
    v_dot2c_f32_bf16 v79, v93, v58
    v_dot2c_f32_bf16 v80, v92, v59
    v_dot2c_f32_bf16 v81, v93, v59
    v_and_b32 v92, 0xffff, v72
    v_and_b32 v93, 0xffff0000, v72
    s_waitcnt vmcnt(12)
    v_dot2c_f32_bf16 v74, v92, v60
    v_dot2c_f32_bf16 v75, v93, v60
    v_dot2c_f32_bf16 v76, v92, v61
    v_dot2c_f32_bf16 v77, v93, v61
    v_dot2c_f32_bf16 v78, v92, v62
    v_dot2c_f32_bf16 v79, v93, v62
    v_dot2c_f32_bf16 v80, v92, v63
    v_dot2c_f32_bf16 v81, v93, v63
    v_and_b32 v92, 0xffff, v73
    v_and_b32 v93, 0xffff0000, v73
    s_waitcnt vmcnt(11)
    v_dot2c_f32_bf16 v74, v92, v64
    v_dot2c_f32_bf16 v75, v93, v64
    v_dot2c_f32_bf16 v76, v92, v65
    v_dot2c_f32_bf16 v77, v93, v65
    v_dot2c_f32_bf16 v78, v92, v66
    v_dot2c_f32_bf16 v79, v93, v66
    v_dot2c_f32_bf16 v80, v92, v67
    v_dot2c_f32_bf16 v81, v93, v67
    v_permlane32_swap_b32 v74, v78
    v_permlane32_swap_b32 v75, v79
    v_permlane32_swap_b32 v76, v80
    v_permlane32_swap_b32 v77, v81
    v_add_f32 v74, v74, v78
    v_add_f32 v75, v75, v79
    v_add_f32 v76, v76, v80
    v_add_f32 v77, v77, v81
    s_nop 0
    v_permlane16_swap_b32 v74, v76
    v_permlane16_swap_b32 v75, v77
    v_add_f32 v74, v74, v76
    v_add_f32 v75, v75, v77
    s_nop 0
    v_add_f32_dpp v76, v74, v74 row_ror:8 row_mask:0xf bank_mask:0x3
    s_nop 1
    v_add_f32_dpp v76, v75, v75 row_ror:8 row_mask:0xf bank_mask:0xc
    ds_write_b32 v87, v76 offset:256
    s_mul_i32 s34, s35, 0x9e3779b1
    s_add_u32 s34, s34, 0x7f4a7c15
    s_waitcnt lgkmcnt(0)
    s_barrier
    ds_read_b128 v[56:59], v89 offset:256
    ds_read_b128 v[92:95], v88
    ds_read_b128 v[96:99], v88 offset:16
    s_waitcnt lgkmcnt(1)
    v_pk_add_f32 v[92:93], v[92:93], v[94:95]
    s_waitcnt lgkmcnt(0)
    v_pk_add_f32 v[96:97], v[96:97], v[98:99]
    v_add_f32 v92, v92, v93
    v_add_f32 v96, v96, v97
    v_mul_f32 v92, 0x3acccccd, v92
    v_mul_f32 v96, 0x3acccccd, v96
    v_fma_f32 v96, -v92, v92, v96
    v_max_f32 v96, 0, v96
    v_cvt_pk_bf16_f32 v96, v96, v96
    v_lshlrev_b32 v96, 16, v96
    v_add_f32 v96, 0x3727c5ac, v96
    v_cvt_pk_bf16_f32 v96, v96, v96
    v_lshlrev_b32 v96, 16, v96
    v_sqrt_f32 v96, v96
    s_nop 0
    v_cvt_pk_bf16_f32 v96, v92, v96
    s_mov_b64 exec, 0xff
    buffer_store_dword v96, v9, s[36:39], s69 offen sc1
    s_mov_b64 exec, -1
    v_add_f32 v56, v56, v57
    v_add_f32 v58, v58, v59
    v_add_f32 v56, v56, v58
    buffer_store_dword v56, v90, s[36:39], s68 offen sc1
    s_cmp_lt_u32 s62, 20
    s_cbranch_scc1 F_conv
    s_cmp_lt_u32 s62, 30
    s_cbranch_scc1 F_sc
    s_waitcnt vmcnt(0)
    s_barrier
    s_lshl_b32 s96, s2, 2
    s_add_u32 s96, s96, 0x1000
    s_cmp_eq_u32 s60, 0
    s_cselect_b32 s96, s96, 0x7f000000
    v_mov_b32 v94, s34
    v_mul_u32_u24 v95, 1536, v1
    s_mov_b32 exec_hi, 0
    s_mov_b32 exec_lo, 0xffffffff
    buffer_store_dword v94, v95, s[36:39], s96 offen sc1
    s_mov_b64 exec, -1
    s_cmp_eq_u32 s62, 30
    s_cbranch_scc0 F_aggp
    s_cmp_eq_u32 s61, 0
    s_cbranch_scc0 F_agg1
    s_mov_b32 s71, 0
    v_lshlrev_b32 v60, 2, v0
    s_lshr_b32 s96, s2, 3
    s_xor_b32 s96, s96, s2
    s_and_b32 s96, s96, 31
    s_mul_i32 s96, s96, 1536
    s_add_u32 s96, s96, 0x1000
    s_mov_b32 s97, 0
Lpoll1:
    v_mov_b32 v61, 0
    buffer_atomic_or v61, v60, s[36:39], s96 offen sc0 sc1
    s_add_u32 s97, s97, 1
    s_cmp_gt_u32 s97, 0x40000
    s_cbranch_scc1 Lpoll1_x
    s_waitcnt vmcnt(0)
    v_cmp_ne_u32 vcc, s34, v61
    s_nop 4
    s_cbranch_vccnz Lpoll1
Lpoll1_x:
    s_waitcnt vmcnt(0)
    s_barrier
    v_lshlrev_b32 v48, 4, v0
    v_min_u32 v48, 2544, v48
    s_mov_b32 s74, 0x43200
    buffer_load_dwordx4 v[24:27], v48, s[36:39], s74 offen sc1
    s_add_u32 s74, s74, 15360
    buffer_load_dwordx4 v[28:31], v48, s[36:39], s74 offen sc1
    s_add_u32 s74, s74, 15360
    buffer_load_dwordx4 v[32:35], v48, s[36:39], s74 offen sc1
    s_add_u32 s74, s74, 15360
    buffer_load_dwordx4 v[36:39], v48, s[36:39], s74 offen sc1
    s_waitcnt vmcnt(2)
    v_add_f32 v24, v24, v28
    s_waitcnt vmcnt(0)
    v_add_f32 v32, v32, v36
    v_add_f32 v24, v24, v32
    v_cvt_pk_bf16_f32 v24, v24, v24
    v_lshlrev_b32 v24, 16, v24
    v_mul_f32 v24, 0xbf317218, v24
    v_add_f32 v25, v25, v29
    v_add_f32 v33, v33, v37
    v_add_f32 v25, v25, v33
    v_cvt_pk_bf16_f32 v25, v25, v25
    v_lshlrev_b32 v25, 16, v25
    v_mul_f32 v25, 0xbf317218, v25
    v_add_f32 v26, v26, v30
    v_add_f32 v34, v34, v38
    v_add_f32 v26, v26, v34
    v_cvt_pk_bf16_f32 v26, v26, v26
    v_lshlrev_b32 v26, 16, v26
    v_mul_f32 v26, 0xbf317218, v26
    v_add_f32 v27, v27, v31
    v_add_f32 v35, v35, v39
    v_add_f32 v27, v27, v35
    v_cvt_pk_bf16_f32 v27, v27, v27
    v_lshlrev_b32 v27, 16, v27
    v_mul_f32 v27, 0xbf317218, v27
    s_mov_b32 s74, 0x56000
    s_cmp_eq_u32 s71, 0
    s_cselect_b32 s74, s74, 0x7f000000
    buffer_store_dwordx4 v[24:27], v48, s[36:39], s74 offen sc1
    s_mov_b32 s71, 216
    s_waitcnt vmcnt(0)
    s_barrier
    s_lshl_b32 s96, s71, 2
    s_add_u32 s96, s96, 0x19000
    s_cmp_eq_u32 s60, 0
    s_cselect_b32 s96, s96, 0x7f000000
    v_mov_b32 v94, s34
    v_mul_u32_u24 v95, 1536, v1
    s_mov_b32 exec_hi, 0
    s_mov_b32 exec_lo, 0xffffffff
    buffer_store_dword v94, v95, s[36:39], s96 offen sc1
    s_mov_b64 exec, -1
F_agg1:
    v_add_u32 v92, 0, v0
    v_lshlrev_b32 v92, 2, v92
    v_cmp_gt_u32 vcc, 80, v0
    s_nop 1
    s_and_saveexec_b64 s[56:57], vcc
    s_cbranch_execz Lg2
    s_lshr_b32 s96, s2, 3
    s_xor_b32 s96, s96, s2
    s_and_b32 s96, s96, 31
    s_mul_i32 s96, s96, 1536
    s_add_u32 s96, s96, 0x19000
    s_mov_b32 s97, 0
Lpoll3:
    v_mov_b32 v93, 0
    buffer_atomic_or v93, v92, s[36:39], s96 offen sc0 sc1
    s_add_u32 s97, s97, 1
    s_cmp_gt_u32 s97, 0x40000
    s_cbranch_scc1 Lpoll3_x
    s_waitcnt vmcnt(0)
    v_cmp_ne_u32 vcc, s34, v93
    s_nop 4
    s_cbranch_vccnz Lpoll3
Lpoll3_x:
    s_waitcnt vmcnt(0)
Lg2:
    s_mov_b64 exec, -1
    s_waitcnt vmcnt(0)
    s_barrier
    s_lshl_b32 s96, s61, 9
    s_add_u32 s96, s96, 0x32000
    s_cmp_eq_u32 s60, 0
    s_cselect_b32 s96, s96, 0x7f000000
    v_mov_b32 v92, s34
    v_mov_b32 v93, 0
    s_mov_b64 exec, 1
    buffer_store_dword v92, v93, s[36:39], s96 offen sc1
    s_mov_b64 exec, -1
    s_branch F_g1w
F_aggp:
    v_add_u32 v92, 0, v0
    v_lshlrev_b32 v92, 2, v92
    v_cmp_gt_u32 vcc, 160, v0
    s_nop 1
    s_and_saveexec_b64 s[56:57], vcc
    s_cbranch_execz Lg4
    s_lshr_b32 s96, s2, 3
    s_xor_b32 s96, s96, s2
    s_and_b32 s96, s96, 31
    s_mul_i32 s96, s96, 1536
    s_add_u32 s96, s96, 0xd000
    s_mov_b32 s97, 0
Lpoll5:
    v_mov_b32 v93, 0
    buffer_atomic_or v93, v92, s[36:39], s96 offen sc0 sc1
    s_add_u32 s97, s97, 1
    s_cmp_gt_u32 s97, 0x40000
    s_cbranch_scc1 Lpoll5_x
    s_waitcnt vmcnt(0)
    v_cmp_ne_u32 vcc, s34, v93
    s_nop 4
    s_cbranch_vccnz Lpoll5
Lpoll5_x:
    s_waitcnt vmcnt(0)
Lg4:
    s_mov_b64 exec, -1
    s_waitcnt vmcnt(0)
    s_barrier
    s_lshl_b32 s96, s61, 9
    s_add_u32 s96, s96, 0x32080
    s_cmp_eq_u32 s60, 0
    s_cselect_b32 s96, s96, 0x7f000000
    v_mov_b32 v92, s34
    v_mov_b32 v93, 0
    s_mov_b64 exec, 1
    buffer_store_dword v92, v93, s[36:39], s96 offen sc1
    s_mov_b64 exec, -1
    v_and_b32 v92, 1, v1
    v_lshlrev_b32 v92, 7, v92
    v_lshlrev_b32 v3, 4, v1
    buffer_load_dword v93, v92, s[36:39], s89 offen offset:0 sc1
    s_waitcnt vmcnt(0)
    v_cmp_ne_u32 s[56:57], s34, v93
    s_nop 1
    s_cmp_lg_u64 s[56:57], 0
    s_cbranch_scc0 F_h0
    s_mov_b32 s97, 0
F_h0_l:
    s_sleep 1
    buffer_load_dword v93, v92, s[36:39], s89 offen offset:0 sc1
    s_add_u32 s97, s97, 1
    s_waitcnt vmcnt(0)
    v_cmp_ne_u32 s[56:57], s34, v93
    s_nop 1
    s_cmp_lg_u64 s[56:57], 0
    s_cbranch_scc0 F_h0
    s_cmp_lt_u32 s97, 0x40000
    s_cbranch_scc1 F_h0_l
F_h0:
    s_mul_i32 s3, s93, 143360
    s_add_u32 s3, s3, 0x900000
    s_mul_i32 s63, s60, 20480
    s_add_u32 s63, s63, s3
    s_mul_i32 s66, s60, 33792
    s_add_u32 m0, s66, 13312
    s_nop 0
    buffer_load_dwordx4 v3, s[36:39], s63 offen offset:0 sc1 lds
    buffer_load_dwordx4 v3, s[36:39], s63 offen offset:1024 sc1 lds
    buffer_load_dwordx4 v3, s[36:39], s63 offen offset:2048 sc1 lds
    buffer_load_dwordx4 v3, s[36:39], s63 offen offset:3072 sc1 lds
    s_add_u32 m0, m0, 4096
    s_add_u32 s63, s63, 4096
    buffer_load_dwordx4 v3, s[36:39], s63 offen offset:0 sc1 lds
    buffer_load_dwordx4 v3, s[36:39], s63 offen offset:1024 sc1 lds
    buffer_load_dwordx4 v3, s[36:39], s63 offen offset:2048 sc1 lds
    buffer_load_dwordx4 v3, s[36:39], s63 offen offset:3072 sc1 lds
    s_add_u32 m0, m0, 4096
    s_add_u32 s63, s63, 4096
    buffer_load_dwordx4 v3, s[36:39], s63 offen offset:0 sc1 lds
    buffer_load_dwordx4 v3, s[36:39], s63 offen offset:1024 sc1 lds
    buffer_load_dwordx4 v3, s[36:39], s63 offen offset:2048 sc1 lds
    buffer_load_dwordx4 v3, s[36:39], s63 offen offset:3072 sc1 lds
    s_add_u32 m0, m0, 4096
    s_add_u32 s63, s63, 4096
    buffer_load_dwordx4 v3, s[36:39], s63 offen offset:0 sc1 lds
    buffer_load_dwordx4 v3, s[36:39], s63 offen offset:1024 sc1 lds
    buffer_load_dwordx4 v3, s[36:39], s63 offen offset:2048 sc1 lds
    buffer_load_dwordx4 v3, s[36:39], s63 offen offset:3072 sc1 lds
    s_add_u32 m0, m0, 4096
    s_add_u32 s63, s63, 4096
    buffer_load_dwordx4 v3, s[36:39], s63 offen offset:0 sc1 lds
    buffer_load_dwordx4 v3, s[36:39], s63 offen offset:1024 sc1 lds
    buffer_load_dwordx4 v3, s[36:39], s63 offen offset:2048 sc1 lds
    buffer_load_dwordx4 v3, s[36:39], s63 offen offset:3072 sc1 lds
    s_lshl_b32 s63, s60, 11
    s_add_u32 m0, s63, 135168
    s_add_u32 s63, s63, s3
    s_add_u32 s63, s63, 81920
    buffer_load_dwordx4 v3, s[36:39], s63 offen offset:0 sc1 lds
    buffer_load_dwordx4 v3, s[36:39], s63 offen offset:1024 sc1 lds
    s_mul_i32 s63, s60, 33792
    s_add_u32 m0, s63, 0
    s_mul_i32 s63, s60, 4096
    s_add_u32 s63, s63, s3
    s_add_u32 s63, s63, 90112
    v_add_u32 v92, 160, v0
    v_lshlrev_b32 v92, 2, v92
    v_cmp_gt_u32 vcc, 57, v0
    s_nop 1
    s_and_saveexec_b64 s[56:57], vcc
    s_cbranch_execz Lg6
    s_lshr_b32 s96, s2, 3
    s_xor_b32 s96, s96, s2
    s_and_b32 s96, s96, 31
    s_mul_i32 s96, s96, 1536
    s_add_u32 s96, s96, 0x19000
    s_mov_b32 s97, 0
Lpoll7:
    v_mov_b32 v93, 0
    buffer_atomic_or v93, v92, s[36:39], s96 offen sc0 sc1
    s_add_u32 s97, s97, 1
    s_cmp_gt_u32 s97, 0x40000
    s_cbranch_scc1 Lpoll7_x
    s_waitcnt vmcnt(0)
    v_cmp_ne_u32 vcc, s34, v93
    s_nop 4
    s_cbranch_vccnz Lpoll7
Lpoll7_x:
    s_waitcnt vmcnt(0)
Lg6:
    s_mov_b64 exec, -1
    s_waitcnt vmcnt(0)
    s_barrier
    s_lshl_b32 s96, s61, 9
    s_add_u32 s96, s96, 0x32100
    s_cmp_eq_u32 s60, 0
    s_cselect_b32 s96, s96, 0x7f000000
    v_mov_b32 v92, s34
    v_mov_b32 v93, 0
    s_mov_b64 exec, 1
    buffer_store_dword v92, v93, s[36:39], s96 offen sc1
    s_mov_b64 exec, -1
    s_branch F_g1x
F_sc:
    s_mul_i32 s71, s61, 10
    s_add_u32 s71, s71, s62
    s_sub_u32 s71, s71, 20
    s_mov_b32 s40, s20
    s_mov_b32 s41, s21
    s_mov_b32 s42, 2211840
    s_mov_b32 s43, 0x20000
    s_lshl2_add_u32 s72, s71, s60
    s_mul_i32 s72, s72, 6912
    s_mul_i32 s73, s60, 8320
    s_mov_b32 m0, s73
    v_lshlrev_b32 v3, 4, v1
    v_lshlrev_b32 v7, 2, v1
    buffer_load_dwordx4 v3, s[40:43], s72 offen offset:0  lds
    buffer_load_dwordx4 v3, s[40:43], s72 offen offset:1024  lds
    buffer_load_dwordx4 v3, s[40:43], s72 offen offset:2048  lds
    s_mov_b64 exec, 0xffffff
    buffer_load_dwordx4 v3, s[40:43], s72 offen offset:3072  lds
    s_mov_b64 exec, -1
    s_add_u32 m0, m0, 4160
    s_add_u32 s72, s72, 3456
    buffer_load_dwordx4 v3, s[40:43], s72 offen offset:0  lds
    buffer_load_dwordx4 v3, s[40:43], s72 offen offset:1024  lds
    buffer_load_dwordx4 v3, s[40:43], s72 offen offset:2048  lds
    s_mov_b64 exec, 0xffffff
    buffer_load_dwordx4 v3, s[40:43], s72 offen offset:3072  lds
    s_mov_b64 exec, -1
    s_waitcnt vmcnt(8)
    s_barrier
    s_lshl_b32 s96, s2, 2
    s_add_u32 s96, s96, 0x1000
    s_cmp_eq_u32 s60, 0
    s_cselect_b32 s96, s96, 0x7f000000
    v_mov_b32 v94, s34
    v_mul_u32_u24 v95, 1536, v1
    s_mov_b32 exec_hi, 0
    s_mov_b32 exec_lo, 0xffffffff
    buffer_store_dword v94, v95, s[36:39], s96 offen sc1
    s_mov_b64 exec, -1
    s_lshr_b32 s72, s71, 2
    s_mov_b32 s64, 0
    s_mov_b32 s65, 0
    s_mul_i32 s73, s72, 3
    s_add_u32 s73, s73, 1
    s_lshl_b32 s73, s73, 0
    s_or_b32 s64, s64, s73
    s_mul_i32 s73, s72, 3
    s_add_u32 s73, s73, 2
    s_lshl_b32 s73, s73, 8
    s_or_b32 s64, s64, s73
    s_mul_i32 s73, s72, 2
    s_add_u32 s73, s73, 60
    s_lshl_b32 s73, s73, 16
    s_or_b32 s64, s64, s73
    s_mul_i32 s73, s72, 2
    s_add_u32 s73, s73, 61
    s_lshl_b32 s73, s73, 24
    s_or_b32 s64, s64, s73
    s_mul_i32 s73, s72, 2
    s_add_u32 s73, s73, 100
    s_lshl_b32 s73, s73, 0
    s_or_b32 s65, s65, s73
    s_mul_i32 s73, s72, 2
    s_add_u32 s73, s73, 101
    s_lshl_b32 s73, s73, 8
    s_or_b32 s65, s65, s73
    s_mul_i32 s73, s72, 3
    s_add_u32 s73, s73, 0
    s_lshl_b32 s73, s73, 16
    s_or_b32 s65, s65, s73
    v_lshrrev_b32 v4, 4, v1
    v_bfe_u32 v5, v1, 2, 2
    v_and_b32 v6, 3, v1
    v_mul_u32_u24 v32, 4160, v5
    v_lshl_add_u32 v32, v6, 3, v32
    v_and_b32 v33, 15, v1
    s_and_b32 s72, s71, 3
    s_lshl_b32 s72, s72, 8
    s_add_u32 s72, s72, 0x900000
    v_lshl_add_u32 v34, v33, 4, s72
    s_lshl_b32 s72, s60, 2
    v_add_u32 v35, s72, v4
    v_cmp_le_u32 s[74:75], 12, v33
    v_cmp_eq_u32 s[76:77], 12, v33
    v_mov_b32 v40, s64
    v_mov_b32 v41, s65
    v_mov_b32 v61, 0
    s_and_b32 s79, s71, 1
    s_lshl_b32 s79, s79, 8
    v_add_u32 v36, 0, v35
    v_mul_u32_u24 v37, 9363, v36
    v_lshrrev_b32 v37, 16, v37
    v_mul_u32_u24 v38, 7, v37
    v_sub_u32 v38, v36, v38
    v_lshl_add_u32 v36, v36, 5, v32
    v_lshlrev_b32 v39, 3, v37
    v_sub_u32 v8, v36, v39
    v_cmp_eq_u32 vcc, 6, v38
    v_lshlrev_b32 v38, 3, v38
    v_lshrrev_b64 v[42:43], v38, v[40:41]
    v_and_b32 v42, 255, v42
    v_mul_u32_u24 v37, 140, v37
    v_add_u32 v42, v42, v37
    v_lshl_add_u32 v16, v42, 10, v34
    s_and_b64 s[40:41], vcc, s[74:75]
    s_and_b64 vcc, vcc, s[76:77]
    v_cndmask_b32 v44, 0, 1.0, vcc
    v_add_u32 v36, 16, v35
    v_mul_u32_u24 v37, 9363, v36
    v_lshrrev_b32 v37, 16, v37
    v_mul_u32_u24 v38, 7, v37
    v_sub_u32 v38, v36, v38
    v_lshl_add_u32 v36, v36, 5, v32
    v_lshlrev_b32 v39, 3, v37
    v_sub_u32 v9, v36, v39
    v_cmp_eq_u32 vcc, 6, v38
    v_lshlrev_b32 v38, 3, v38
    v_lshrrev_b64 v[42:43], v38, v[40:41]
    v_and_b32 v42, 255, v42
    v_mul_u32_u24 v37, 140, v37
    v_add_u32 v42, v42, v37
    v_lshl_add_u32 v17, v42, 10, v34
    s_and_b64 s[42:43], vcc, s[74:75]
    s_and_b64 vcc, vcc, s[76:77]
    v_cndmask_b32 v46, 0, 1.0, vcc
    v_add_u32 v36, 32, v35
    v_mul_u32_u24 v37, 9363, v36
    v_lshrrev_b32 v37, 16, v37
    v_mul_u32_u24 v38, 7, v37
    v_sub_u32 v38, v36, v38
    v_lshl_add_u32 v36, v36, 5, v32
    v_lshlrev_b32 v39, 3, v37
    v_sub_u32 v10, v36, v39
    v_cmp_eq_u32 vcc, 6, v38
    v_lshlrev_b32 v38, 3, v38
    v_lshrrev_b64 v[42:43], v38, v[40:41]
    v_and_b32 v42, 255, v42
    v_mul_u32_u24 v37, 140, v37
    v_add_u32 v42, v42, v37
    v_lshl_add_u32 v18, v42, 10, v34
    s_and_b64 s[44:45], vcc, s[74:75]
    s_and_b64 vcc, vcc, s[76:77]
    v_cndmask_b32 v48, 0, 1.0, vcc
    v_add_u32 v36, 48, v35
    v_mul_u32_u24 v37, 9363, v36
    v_lshrrev_b32 v37, 16, v37
    v_mul_u32_u24 v38, 7, v37
    v_sub_u32 v38, v36, v38
    v_lshl_add_u32 v36, v36, 5, v32
    v_lshlrev_b32 v39, 3, v37
    v_sub_u32 v11, v36, v39
    v_cmp_eq_u32 vcc, 6, v38
    v_lshlrev_b32 v38, 3, v38
    v_lshrrev_b64 v[42:43], v38, v[40:41]
    v_and_b32 v42, 255, v42
    v_mul_u32_u24 v37, 140, v37
    v_add_u32 v42, v42, v37
    v_lshl_add_u32 v19, v42, 10, v34
    s_and_b64 s[46:47], vcc, s[74:75]
    s_and_b64 vcc, vcc, s[76:77]
    v_cndmask_b32 v50, 0, 1.0, vcc
    v_add_u32 v36, 64, v35
    v_mul_u32_u24 v37, 9363, v36
    v_lshrrev_b32 v37, 16, v37
    v_mul_u32_u24 v38, 7, v37
    v_sub_u32 v38, v36, v38
    v_lshl_add_u32 v36, v36, 5, v32
    v_lshlrev_b32 v39, 3, v37
    v_sub_u32 v12, v36, v39
    v_cmp_eq_u32 vcc, 6, v38
    v_lshlrev_b32 v38, 3, v38
    v_lshrrev_b64 v[42:43], v38, v[40:41]
    v_and_b32 v42, 255, v42
    v_mul_u32_u24 v37, 140, v37
    v_add_u32 v42, v42, v37
    v_lshl_add_u32 v20, v42, 10, v34
    s_and_b64 s[48:49], vcc, s[74:75]
    s_and_b64 vcc, vcc, s[76:77]
    v_cndmask_b32 v52, 0, 1.0, vcc
    v_add_u32 v36, 80, v35
    v_mul_u32_u24 v37, 9363, v36
    v_lshrrev_b32 v37, 16, v37
    v_mul_u32_u24 v38, 7, v37
    v_sub_u32 v38, v36, v38
    v_lshl_add_u32 v36, v36, 5, v32
    v_lshlrev_b32 v39, 3, v37
    v_sub_u32 v13, v36, v39
    v_cmp_eq_u32 vcc, 6, v38
    v_lshlrev_b32 v38, 3, v38
    v_lshrrev_b64 v[42:43], v38, v[40:41]
    v_and_b32 v42, 255, v42
    v_mul_u32_u24 v37, 140, v37
    v_add_u32 v42, v42, v37
    v_lshl_add_u32 v21, v42, 10, v34
    s_and_b64 s[50:51], vcc, s[74:75]
    s_and_b64 vcc, vcc, s[76:77]
    v_cndmask_b32 v54, 0, 1.0, vcc
    v_add_u32 v36, 96, v35
    v_mul_u32_u24 v37, 9363, v36
    v_lshrrev_b32 v37, 16, v37
    v_mul_u32_u24 v38, 7, v37
    v_sub_u32 v38, v36, v38
    v_lshl_add_u32 v36, v36, 5, v32
    v_lshlrev_b32 v39, 3, v37
    v_sub_u32 v14, v36, v39
    v_cmp_eq_u32 vcc, 6, v38
    v_lshlrev_b32 v38, 3, v38
    v_lshrrev_b64 v[42:43], v38, v[40:41]
    v_and_b32 v42, 255, v42
    v_mul_u32_u24 v37, 140, v37
    v_add_u32 v42, v42, v37
    v_lshl_add_u32 v22, v42, 10, v34
    s_and_b64 s[52:53], vcc, s[74:75]
    s_and_b64 vcc, vcc, s[76:77]
    v_cndmask_b32 v56, 0, 1.0, vcc
    v_mov_b32 v236, -1
    v_mov_b32 v237, -1
    v_mov_b32 v238, -1
    v_mov_b32 v239, -1
    v_and_b32 v60, 1, v4
    v_lshl_add_u32 v60, v60, 2, v6
    v_lshlrev_b32 v60, 2, v60
    v_mul_u32_u24 v61, 15360, v5
    v_add_u32 v60, v60, v61
    v_cmp_gt_u32 vcc, 32, v1
    v_mov_b32 v61, 2560
    s_nop 0
    v_cndmask_b32 v61, 0, v61, vcc
    v_add_u32 v60, v60, v61
    v_cndmask_b32 v59, 0, 1.0, vcc
    s_lshl_b32 s72, s71, 5
    s_add_u32 s78, s72, 0x41e00
    v_mov_b32 v61, 0
    s_waitcnt vmcnt(1)
    s_barrier
    s_lshr_b32 s72, s71, 3
    v_lshrrev_b32 v92, 2, v1
    v_mul_u32_u24 v92, 10, v92
    v_add_u32 v92, s72, v92
    v_add_u32 v92, 30, v92
    v_lshl_add_u32 v92, v92, 2, v6
    v_lshlrev_b32 v92, 2, v92
    v_mov_b32 v93, 0
    s_lshr_b32 s96, s2, 3
    s_xor_b32 s96, s96, s2
    s_and_b32 s96, s96, 31
    s_mul_i32 s96, s96, 1536
    s_add_u32 s96, s96, 0x1000
    s_mov_b64 exec, 0xff
    buffer_atomic_or v93, v92, s[36:39], s96 offen sc0 sc1
    s_mov_b64 exec, -1
    ds_read_b64_tr_b16 v[64:65], v8
    ds_read_b64_tr_b16 v[66:67], v8 offset:16640
    ds_read_b64_tr_b16 v[68:69], v9
    ds_read_b64_tr_b16 v[70:71], v9 offset:16640
    ds_read_b64_tr_b16 v[72:73], v10
    ds_read_b64_tr_b16 v[74:75], v10 offset:16640
    ds_read_b64_tr_b16 v[76:77], v11
    ds_read_b64_tr_b16 v[78:79], v11 offset:16640
    ds_read_b64_tr_b16 v[80:81], v12
    ds_read_b64_tr_b16 v[82:83], v12 offset:16640
    ds_read_b64_tr_b16 v[84:85], v13
    ds_read_b64_tr_b16 v[86:87], v13 offset:16640
    ds_read_b64_tr_b16 v[88:89], v14
    ds_read_b64_tr_b16 v[90:91], v14 offset:16640
    s_waitcnt lgkmcnt(13)
    v_cndmask_b32 v64, v64, v61, s[40:41]
    v_lshlrev_b32 v96, 16, v64
    v_and_b32 v97, 0xffff0000, v64
    v_cndmask_b32 v65, v65, v61, s[40:41]
    v_lshlrev_b32 v98, 16, v65
    v_and_b32 v99, 0xffff0000, v65
    s_waitcnt lgkmcnt(12)
    v_cndmask_b32 v66, v66, v61, s[40:41]
    v_lshlrev_b32 v100, 16, v66
    v_and_b32 v101, 0xffff0000, v66
    v_cndmask_b32 v67, v67, v61, s[40:41]
    v_lshlrev_b32 v102, 16, v67
    v_and_b32 v103, 0xffff0000, v67
    s_waitcnt lgkmcnt(11)
    v_cndmask_b32 v68, v68, v61, s[42:43]
    v_lshlrev_b32 v104, 16, v68
    v_and_b32 v105, 0xffff0000, v68
    v_cndmask_b32 v69, v69, v61, s[42:43]
    v_lshlrev_b32 v106, 16, v69
    v_and_b32 v107, 0xffff0000, v69
    s_waitcnt lgkmcnt(10)
    v_cndmask_b32 v70, v70, v61, s[42:43]
    v_lshlrev_b32 v108, 16, v70
    v_and_b32 v109, 0xffff0000, v70
    v_cndmask_b32 v71, v71, v61, s[42:43]
    v_lshlrev_b32 v110, 16, v71
    v_and_b32 v111, 0xffff0000, v71
    s_waitcnt lgkmcnt(9)
    v_cndmask_b32 v72, v72, v61, s[44:45]
    v_lshlrev_b32 v112, 16, v72
    v_and_b32 v113, 0xffff0000, v72
    v_cndmask_b32 v73, v73, v61, s[44:45]
    v_lshlrev_b32 v114, 16, v73
    v_and_b32 v115, 0xffff0000, v73
    s_waitcnt lgkmcnt(8)
    v_cndmask_b32 v74, v74, v61, s[44:45]
    v_lshlrev_b32 v116, 16, v74
    v_and_b32 v117, 0xffff0000, v74
    v_cndmask_b32 v75, v75, v61, s[44:45]
    v_lshlrev_b32 v118, 16, v75
    v_and_b32 v119, 0xffff0000, v75
    s_waitcnt lgkmcnt(7)
    v_cndmask_b32 v76, v76, v61, s[46:47]
    v_lshlrev_b32 v120, 16, v76
    v_and_b32 v121, 0xffff0000, v76
    v_cndmask_b32 v77, v77, v61, s[46:47]
    v_lshlrev_b32 v122, 16, v77
    v_and_b32 v123, 0xffff0000, v77
    s_waitcnt lgkmcnt(6)
    v_cndmask_b32 v78, v78, v61, s[46:47]
    v_lshlrev_b32 v124, 16, v78
    v_and_b32 v125, 0xffff0000, v78
    v_cndmask_b32 v79, v79, v61, s[46:47]
    v_lshlrev_b32 v126, 16, v79
    v_and_b32 v127, 0xffff0000, v79
    s_waitcnt lgkmcnt(5)
    v_cndmask_b32 v80, v80, v61, s[48:49]
    v_lshlrev_b32 v128, 16, v80
    v_and_b32 v129, 0xffff0000, v80
    v_cndmask_b32 v81, v81, v61, s[48:49]
    v_lshlrev_b32 v130, 16, v81
    v_and_b32 v131, 0xffff0000, v81
    s_waitcnt lgkmcnt(4)
    v_cndmask_b32 v82, v82, v61, s[48:49]
    v_lshlrev_b32 v132, 16, v82
    v_and_b32 v133, 0xffff0000, v82
    v_cndmask_b32 v83, v83, v61, s[48:49]
    v_lshlrev_b32 v134, 16, v83
    v_and_b32 v135, 0xffff0000, v83
    s_waitcnt lgkmcnt(3)
    v_cndmask_b32 v84, v84, v61, s[50:51]
    v_lshlrev_b32 v136, 16, v84
    v_and_b32 v137, 0xffff0000, v84
    v_cndmask_b32 v85, v85, v61, s[50:51]
    v_lshlrev_b32 v138, 16, v85
    v_and_b32 v139, 0xffff0000, v85
    s_waitcnt lgkmcnt(2)
    v_cndmask_b32 v86, v86, v61, s[50:51]
    v_lshlrev_b32 v140, 16, v86
    v_and_b32 v141, 0xffff0000, v86
    v_cndmask_b32 v87, v87, v61, s[50:51]
    v_lshlrev_b32 v142, 16, v87
    v_and_b32 v143, 0xffff0000, v87
    s_waitcnt lgkmcnt(1)
    v_cndmask_b32 v88, v88, v61, s[52:53]
    v_lshlrev_b32 v144, 16, v88
    v_and_b32 v145, 0xffff0000, v88
    v_cndmask_b32 v89, v89, v61, s[52:53]
    v_lshlrev_b32 v146, 16, v89
    v_and_b32 v147, 0xffff0000, v89
    s_waitcnt lgkmcnt(0)
    v_cndmask_b32 v90, v90, v61, s[52:53]
    v_lshlrev_b32 v148, 16, v90
    v_and_b32 v149, 0xffff0000, v90
    v_cndmask_b32 v91, v91, v61, s[52:53]
    v_lshlrev_b32 v150, 16, v91
    v_and_b32 v151, 0xffff0000, v91
    s_mov_b64 exec, 0xff
    s_waitcnt vmcnt(0)
    v_cmp_ne_u32 vcc, s34, v93
    s_nop 4
    s_cbranch_vccz F_p2ok
    s_mov_b32 s97, 0
Lpoll8:
    v_mov_b32 v93, 0
    buffer_atomic_or v93, v92, s[36:39], s96 offen sc0 sc1
    s_add_u32 s97, s97, 1
    s_cmp_gt_u32 s97, 0x40000
    s_cbranch_scc1 Lpoll8_x
    s_waitcnt vmcnt(0)
    v_cmp_ne_u32 vcc, s34, v93
    s_nop 4
    s_cbranch_vccnz Lpoll8
Lpoll8_x:
    s_waitcnt vmcnt(0)
F_p2ok:
    s_mov_b64 exec, -1
    buffer_load_dword v62, v60, s[36:39], s78 offen sc1
    s_waitcnt vmcnt(0)
    v_add_f32_dpp v62, v62, v62 row_ror:4 row_mask:0xf bank_mask:0xf
    s_nop 1
    v_add_f32_dpp v62, v62, v62 row_ror:8 row_mask:0xf bank_mask:0xf
    v_cvt_pk_bf16_f32 v62, v62, v62
    v_lshlrev_b32 v62, 16, v62
    v_add_f32 v62, v59, v62
    v_cvt_pk_bf16_f32 v62, v62, v62
    v_lshlrev_b32 v62, 16, v62
    s_nop 0
    v_readlane_b32 s80, v62, 0
    v_readlane_b32 s81, v62, 1
    v_readlane_b32 s82, v62, 2
    v_readlane_b32 s83, v62, 3
    v_readlane_b32 s84, v62, 16
    v_readlane_b32 s85, v62, 17
    v_readlane_b32 s86, v62, 18
    v_readlane_b32 s87, v62, 19
    v_pk_fma_f32 v[152:153], v[96:97], s[80:81], v[44:45] op_sel_hi:[1,1,0]
    v_pk_fma_f32 v[154:155], v[98:99], s[82:83], v[44:45] op_sel_hi:[1,1,0]
    v_pk_fma_f32 v[156:157], v[100:101], s[84:85], v[44:45] op_sel_hi:[1,1,0]
    v_pk_fma_f32 v[158:159], v[102:103], s[86:87], v[44:45] op_sel_hi:[1,1,0]
    v_cvt_pk_bf16_f32 v64, v152, v153
    v_cvt_pk_bf16_f32 v65, v154, v155
    v_cvt_pk_bf16_f32 v66, v156, v157
    v_cvt_pk_bf16_f32 v67, v158, v159
    buffer_store_dwordx4 v[64:67], v16, s[36:39], 0 offen sc1
    v_pk_fma_f32 v[160:161], v[104:105], s[80:81], v[46:47] op_sel_hi:[1,1,0]
    v_pk_fma_f32 v[162:163], v[106:107], s[82:83], v[46:47] op_sel_hi:[1,1,0]
    v_pk_fma_f32 v[164:165], v[108:109], s[84:85], v[46:47] op_sel_hi:[1,1,0]
    v_pk_fma_f32 v[166:167], v[110:111], s[86:87], v[46:47] op_sel_hi:[1,1,0]
    v_cvt_pk_bf16_f32 v68, v160, v161
    v_cvt_pk_bf16_f32 v69, v162, v163
    v_cvt_pk_bf16_f32 v70, v164, v165
    v_cvt_pk_bf16_f32 v71, v166, v167
    buffer_store_dwordx4 v[68:71], v17, s[36:39], 0 offen sc1
    v_pk_fma_f32 v[168:169], v[112:113], s[80:81], v[48:49] op_sel_hi:[1,1,0]
    v_pk_fma_f32 v[170:171], v[114:115], s[82:83], v[48:49] op_sel_hi:[1,1,0]
    v_pk_fma_f32 v[172:173], v[116:117], s[84:85], v[48:49] op_sel_hi:[1,1,0]
    v_pk_fma_f32 v[174:175], v[118:119], s[86:87], v[48:49] op_sel_hi:[1,1,0]
    v_cvt_pk_bf16_f32 v72, v168, v169
    v_cvt_pk_bf16_f32 v73, v170, v171
    v_cvt_pk_bf16_f32 v74, v172, v173
    v_cvt_pk_bf16_f32 v75, v174, v175
    buffer_store_dwordx4 v[72:75], v18, s[36:39], 0 offen sc1
    v_pk_fma_f32 v[176:177], v[120:121], s[80:81], v[50:51] op_sel_hi:[1,1,0]
    v_pk_fma_f32 v[178:179], v[122:123], s[82:83], v[50:51] op_sel_hi:[1,1,0]
    v_pk_fma_f32 v[180:181], v[124:125], s[84:85], v[50:51] op_sel_hi:[1,1,0]
    v_pk_fma_f32 v[182:183], v[126:127], s[86:87], v[50:51] op_sel_hi:[1,1,0]
    v_cvt_pk_bf16_f32 v76, v176, v177
    v_cvt_pk_bf16_f32 v77, v178, v179
    v_cvt_pk_bf16_f32 v78, v180, v181
    v_cvt_pk_bf16_f32 v79, v182, v183
    buffer_store_dwordx4 v[76:79], v19, s[36:39], 0 offen sc1
    v_pk_fma_f32 v[184:185], v[128:129], s[80:81], v[52:53] op_sel_hi:[1,1,0]
    v_pk_fma_f32 v[186:187], v[130:131], s[82:83], v[52:53] op_sel_hi:[1,1,0]
    v_pk_fma_f32 v[188:189], v[132:133], s[84:85], v[52:53] op_sel_hi:[1,1,0]
    v_pk_fma_f32 v[190:191], v[134:135], s[86:87], v[52:53] op_sel_hi:[1,1,0]
    v_cvt_pk_bf16_f32 v80, v184, v185
    v_cvt_pk_bf16_f32 v81, v186, v187
    v_cvt_pk_bf16_f32 v82, v188, v189
    v_cvt_pk_bf16_f32 v83, v190, v191
    buffer_store_dwordx4 v[80:83], v20, s[36:39], 0 offen sc1
    v_pk_fma_f32 v[192:193], v[136:137], s[80:81], v[54:55] op_sel_hi:[1,1,0]
    v_pk_fma_f32 v[194:195], v[138:139], s[82:83], v[54:55] op_sel_hi:[1,1,0]
    v_pk_fma_f32 v[196:197], v[140:141], s[84:85], v[54:55] op_sel_hi:[1,1,0]
    v_pk_fma_f32 v[198:199], v[142:143], s[86:87], v[54:55] op_sel_hi:[1,1,0]
    v_cvt_pk_bf16_f32 v84, v192, v193
    v_cvt_pk_bf16_f32 v85, v194, v195
    v_cvt_pk_bf16_f32 v86, v196, v197
    v_cvt_pk_bf16_f32 v87, v198, v199
    buffer_store_dwordx4 v[84:87], v21, s[36:39], 0 offen sc1
    v_pk_fma_f32 v[200:201], v[144:145], s[80:81], v[56:57] op_sel_hi:[1,1,0]
    v_pk_fma_f32 v[202:203], v[146:147], s[82:83], v[56:57] op_sel_hi:[1,1,0]
    v_pk_fma_f32 v[204:205], v[148:149], s[84:85], v[56:57] op_sel_hi:[1,1,0]
    v_pk_fma_f32 v[206:207], v[150:151], s[86:87], v[56:57] op_sel_hi:[1,1,0]
    v_cvt_pk_bf16_f32 v88, v200, v201
    v_cvt_pk_bf16_f32 v89, v202, v203
    v_cvt_pk_bf16_f32 v90, v204, v205
    v_cvt_pk_bf16_f32 v91, v206, v207
    buffer_store_dwordx4 v[88:91], v22, s[36:39], 0 offen sc1
    v_readlane_b32 s80, v62, 32
    v_readlane_b32 s81, v62, 33
    v_readlane_b32 s82, v62, 34
    v_readlane_b32 s83, v62, 35
    v_readlane_b32 s84, v62, 48
    v_readlane_b32 s85, v62, 49
    v_readlane_b32 s86, v62, 50
    v_readlane_b32 s87, v62, 51
    s_mul_i32 s72, s71, 14336
    s_lshl_b32 s73, s60, 8
    v_pk_add_f32 v[152:153], v[152:153], v[154:155]
    v_pk_mul_f32 v[96:97], v[96:97], s[80:81]
    v_pk_add_f32 v[156:157], v[156:157], v[158:159]
    v_pk_fma_f32 v[96:97], v[98:99], s[82:83], v[96:97]
    v_pk_add_f32 v[152:153], v[152:153], v[156:157]
    v_pk_fma_f32 v[96:97], v[100:101], s[84:85], v[96:97]
    v_add_f32 v152, v152, v153
    v_pk_fma_f32 v[96:97], v[102:103], s[86:87], v[96:97]
    v_add_f32 v96, v96, v97
    v_pk_add_f32 v[160:161], v[160:161], v[162:163]
    v_pk_mul_f32 v[104:105], v[104:105], s[80:81]
    v_pk_add_f32 v[164:165], v[164:165], v[166:167]
    v_pk_fma_f32 v[104:105], v[106:107], s[82:83], v[104:105]
    v_pk_add_f32 v[160:161], v[160:161], v[164:165]
    v_pk_fma_f32 v[104:105], v[108:109], s[84:85], v[104:105]
    v_add_f32 v160, v160, v161
    v_pk_fma_f32 v[104:105], v[110:111], s[86:87], v[104:105]
    v_add_f32 v104, v104, v105
    v_pk_add_f32 v[168:169], v[168:169], v[170:171]
    v_pk_mul_f32 v[112:113], v[112:113], s[80:81]
    v_pk_add_f32 v[172:173], v[172:173], v[174:175]
    v_pk_fma_f32 v[112:113], v[114:115], s[82:83], v[112:113]
    v_pk_add_f32 v[168:169], v[168:169], v[172:173]
    v_pk_fma_f32 v[112:113], v[116:117], s[84:85], v[112:113]
    v_add_f32 v168, v168, v169
    v_pk_fma_f32 v[112:113], v[118:119], s[86:87], v[112:113]
    v_add_f32 v112, v112, v113
    v_pk_add_f32 v[176:177], v[176:177], v[178:179]
    v_pk_mul_f32 v[120:121], v[120:121], s[80:81]
    v_pk_add_f32 v[180:181], v[180:181], v[182:183]
    v_pk_fma_f32 v[120:121], v[122:123], s[82:83], v[120:121]
    v_pk_add_f32 v[176:177], v[176:177], v[180:181]
    v_pk_fma_f32 v[120:121], v[124:125], s[84:85], v[120:121]
    v_add_f32 v176, v176, v177
    v_pk_fma_f32 v[120:121], v[126:127], s[86:87], v[120:121]
    v_add_f32 v120, v120, v121
    v_pk_add_f32 v[184:185], v[184:185], v[186:187]
    v_pk_mul_f32 v[128:129], v[128:129], s[80:81]
    v_pk_add_f32 v[188:189], v[188:189], v[190:191]
    v_pk_fma_f32 v[128:129], v[130:131], s[82:83], v[128:129]
    v_pk_add_f32 v[184:185], v[184:185], v[188:189]
    v_pk_fma_f32 v[128:129], v[132:133], s[84:85], v[128:129]
    v_add_f32 v184, v184, v185
    v_pk_fma_f32 v[128:129], v[134:135], s[86:87], v[128:129]
    v_add_f32 v128, v128, v129
    v_pk_add_f32 v[192:193], v[192:193], v[194:195]
    v_pk_mul_f32 v[136:137], v[136:137], s[80:81]
    v_pk_add_f32 v[196:197], v[196:197], v[198:199]
    v_pk_fma_f32 v[136:137], v[138:139], s[82:83], v[136:137]
    v_pk_add_f32 v[192:193], v[192:193], v[196:197]
    v_pk_fma_f32 v[136:137], v[140:141], s[84:85], v[136:137]
    v_add_f32 v192, v192, v193
    v_pk_fma_f32 v[136:137], v[142:143], s[86:87], v[136:137]
    v_add_f32 v136, v136, v137
    v_pk_add_f32 v[200:201], v[200:201], v[202:203]
    v_pk_mul_f32 v[144:145], v[144:145], s[80:81]
    v_pk_add_f32 v[204:205], v[204:205], v[206:207]
    v_pk_fma_f32 v[144:145], v[146:147], s[82:83], v[144:145]
    v_pk_add_f32 v[200:201], v[200:201], v[204:205]
    v_pk_fma_f32 v[144:145], v[148:149], s[84:85], v[144:145]
    v_add_f32 v200, v200, v201
    v_pk_fma_f32 v[144:145], v[150:151], s[86:87], v[144:145]
    v_add_f32 v144, v144, v145
    s_waitcnt vmcnt(0)
    s_barrier
    s_lshl_b32 s96, s71, 2
    s_add_u32 s96, s96, 0x19000
    s_cmp_eq_u32 s60, 0
    s_cselect_b32 s96, s96, 0x7f000000
    v_mov_b32 v92, s34
    v_mul_u32_u24 v93, 1536, v1
    s_mov_b32 exec_hi, 0
    s_mov_b32 exec_lo, 0xffffffff
    buffer_store_dword v92, v93, s[36:39], s96 offen sc1
    s_mov_b64 exec, -1
    s_add_u32 s72, s72, s73
    s_add_u32 s72, s72, 0xe80000
    s_add_u32 s73, s72, 7168
    buffer_store_dword v152, v7, s[36:39], s72 offen offset:0 sc1
    buffer_store_dword v96, v7, s[36:39], s73 offen offset:0 sc1
    buffer_store_dword v160, v7, s[36:39], s72 offen offset:1024 sc1
    buffer_store_dword v104, v7, s[36:39], s73 offen offset:1024 sc1
    buffer_store_dword v168, v7, s[36:39], s72 offen offset:2048 sc1
    buffer_store_dword v112, v7, s[36:39], s73 offen offset:2048 sc1
    buffer_store_dword v176, v7, s[36:39], s72 offen offset:3072 sc1
    buffer_store_dword v120, v7, s[36:39], s73 offen offset:3072 sc1
    s_add_u32 s72, s72, 4096
    s_add_u32 s73, s73, 4096
    buffer_store_dword v184, v7, s[36:39], s72 offen offset:0 sc1
    buffer_store_dword v128, v7, s[36:39], s73 offen offset:0 sc1
    buffer_store_dword v192, v7, s[36:39], s72 offen offset:1024 sc1
    buffer_store_dword v136, v7, s[36:39], s73 offen offset:1024 sc1
    buffer_store_dword v200, v7, s[36:39], s72 offen offset:2048 sc1
    buffer_store_dword v144, v7, s[36:39], s73 offen offset:2048 sc1
    s_cmp_lt_u32 s71, 56
    s_cbranch_scc0 F_agg
    s_mov_b32 s44, s22
    s_mov_b32 s45, s23
    s_mov_b32 s46, 2211840
    s_mov_b32 s47, 0x20000
    s_lshr_b32 s73, s60, 1
    s_mul_i32 s74, s71, 9363
    s_lshr_b32 s74, s74, 16
    s_mul_i32 s75, s74, 7
    s_sub_u32 s75, s71, s75
    s_lshl_b32 s74, s74, 1
    s_cmp_ge_u32 s75, 3
    s_cselect_b32 s76, 1, 0
    s_cselect_b32 s77, 3, 0
    s_sub_u32 s77, s75, s77
    s_lshl_b32 s77, s77, 1
    s_add_u32 s77, s77, s73
    s_cmp_eq_u32 s75, 6
    s_cselect_b32 s76, s73, s76
    s_cselect_b32 s77, 6, s77
    s_add_u32 s74, s74, s76
    s_mul_i32 s74, s74, 108
    s_lshl4_add_u32 s74, s77, s74
    s_and_b32 s76, s60, 1
    s_lshl3_add_u32 s74, s76, s74
    s_mul_i32 s74, s74, 1280
    s_cmp_lt_u32 s71, 56
    s_cselect_b32 s74, s74, 0x7f000000
    s_lshl3_add_u32 s77, s76, s77
    s_mul_i32 m0, s60, 33792
    s_nop 0
    buffer_load_dwordx4 v3, s[44:47], s74 offen  lds
    buffer_load_dword v7, s[44:47], s74 offen offset:1024  lds
    s_add_u32 m0, m0, 1344
    s_add_u32 s74, s74, 1280
    buffer_load_dwordx4 v3, s[44:47], s74 offen  lds
    buffer_load_dword v7, s[44:47], s74 offen offset:1024  lds
    s_add_u32 m0, m0, 1344
    s_add_u32 s74, s74, 1280
    buffer_load_dwordx4 v3, s[44:47], s74 offen  lds
    buffer_load_dword v7, s[44:47], s74 offen offset:1024  lds
    s_add_u32 m0, m0, 1344
    s_add_u32 s74, s74, 1280
    buffer_load_dwordx4 v3, s[44:47], s74 offen  lds
    buffer_load_dword v7, s[44:47], s74 offen offset:1024  lds
    s_add_u32 m0, m0, 1344
    s_add_u32 s74, s74, 1280
    s_cmp_eq_u32 s77, 14
    s_cselect_b32 s74, 0x7f000000, s74
    buffer_load_dwordx4 v3, s[44:47], s74 offen  lds
    buffer_load_dword v7, s[44:47], s74 offen offset:1024  lds
    s_add_u32 m0, m0, 1344
    s_add_u32 s74, s74, 1280
    buffer_load_dwordx4 v3, s[44:47], s74 offen  lds
    buffer_load_dword v7, s[44:47], s74 offen offset:1024  lds
    s_add_u32 m0, m0, 1344
    s_add_u32 s74, s74, 1280
    buffer_load_dwordx4 v3, s[44:47], s74 offen  lds
    buffer_load_dword v7, s[44:47], s74 offen offset:1024  lds
    s_add_u32 m0, m0, 1344
    s_add_u32 s74, s74, 1280
    buffer_load_dwordx4 v3, s[44:47], s74 offen  lds
    buffer_load_dword v7, s[44:47], s74 offen offset:1024  lds
    s_add_u32 s73, s71, 80
    s_waitcnt vmcnt(16)
    s_barrier
    s_lshl_b32 s96, s73, 2
    s_add_u32 s96, s96, 0x19000
    s_cmp_eq_u32 s60, 0
    s_cselect_b32 s96, s96, 0x7f000000
    v_mov_b32 v94, s34
    v_mul_u32_u24 v95, 1536, v1
    s_mov_b32 exec_hi, 0
    s_mov_b32 exec_lo, 0xffffffff
    buffer_store_dword v94, v95, s[36:39], s96 offen sc1
    s_mov_b64 exec, -1
    v_and_b32 v8, 1, v4
    v_lshl_add_u32 v8, v8, 2, v5
    v_mul_u32_u24 v8, 1344, v8
    v_lshrrev_b32 v9, 1, v4
    v_mul_u32_u24 v9, 33792, v9
    s_mul_i32 s75, s60, 320
    v_add3_u32 v8, v8, v9, s75
    s_mov_b32 s74, 67584
    v_lshl_add_u32 v9, v6, 3, v8
    v_lshl_add_u32 v8, v6, 4, v8
    v_add_u32 v10, s74, v8
    v_add_u32 v11, s74, v9
    s_mul_i32 s75, s60, 573440
    s_mul_i32 s76, s71, 5120
    s_add_u32 s75, s75, s76
    s_add_u32 s75, s75, 0xc00000
    s_cmp_lt_u32 s71, 56
    s_cselect_b32 s75, s75, 0x7f000000
    s_waitcnt vmcnt(0)
    s_barrier
    ds_read_b64_tr_b16 v[96:97], v8 offset:0
    ds_read_b64_tr_b16 v[98:99], v10 offset:0
    ds_read_b64_tr_b16 v[100:101], v8 offset:8
    ds_read_b64_tr_b16 v[102:103], v10 offset:8
    ds_read_b64_tr_b16 v[104:105], v8 offset:64
    ds_read_b64_tr_b16 v[106:107], v10 offset:64
    ds_read_b64_tr_b16 v[108:109], v8 offset:72
    ds_read_b64_tr_b16 v[110:111], v10 offset:72
    ds_read_b64_tr_b16 v[112:113], v9 offset:128
    ds_read_b64_tr_b16 v[114:115], v11 offset:128
    s_waitcnt lgkmcnt(8)
    buffer_store_dwordx4 v[96:99], v3, s[36:39], s75 offen offset:0 sc1
    ds_read_b64_tr_b16 v[116:117], v8 offset:160
    ds_read_b64_tr_b16 v[118:119], v10 offset:160
    s_waitcnt lgkmcnt(8)
    buffer_store_dwordx4 v[100:103], v3, s[36:39], s75 offen offset:1024 sc1
    ds_read_b64_tr_b16 v[120:121], v8 offset:168
    ds_read_b64_tr_b16 v[122:123], v10 offset:168
    s_waitcnt lgkmcnt(8)
    buffer_store_dwordx4 v[104:107], v3, s[36:39], s75 offen offset:2048 sc1
    ds_read_b64_tr_b16 v[124:125], v8 offset:224
    ds_read_b64_tr_b16 v[126:127], v10 offset:224
    s_waitcnt lgkmcnt(8)
    buffer_store_dwordx4 v[108:111], v3, s[36:39], s75 offen offset:3072 sc1
    ds_read_b64_tr_b16 v[128:129], v8 offset:232
    ds_read_b64_tr_b16 v[130:131], v10 offset:232
    s_add_u32 s76, s75, 4096
    s_waitcnt lgkmcnt(8)
    buffer_store_dwordx4 v[112:115], v3, s[36:39], s76 offen sc1
    s_add_u32 s75, s75, 286720
    ds_read_b64_tr_b16 v[132:133], v9 offset:288
    ds_read_b64_tr_b16 v[134:135], v11 offset:288
    s_waitcnt lgkmcnt(8)
    buffer_store_dwordx4 v[116:119], v3, s[36:39], s75 offen offset:0 sc1
    s_waitcnt lgkmcnt(6)
    buffer_store_dwordx4 v[120:123], v3, s[36:39], s75 offen offset:1024 sc1
    s_waitcnt lgkmcnt(4)
    buffer_store_dwordx4 v[124:127], v3, s[36:39], s75 offen offset:2048 sc1
    s_waitcnt lgkmcnt(2)
    buffer_store_dwordx4 v[128:131], v3, s[36:39], s75 offen offset:3072 sc1
    s_add_u32 s76, s75, 4096
    s_waitcnt lgkmcnt(0)
    buffer_store_dwordx4 v[132:135], v3, s[36:39], s76 offen sc1
    s_add_u32 s75, s75, 286720
    s_add_u32 s73, s71, 160
    s_waitcnt vmcnt(0)
    s_barrier
    s_lshl_b32 s96, s73, 2
    s_add_u32 s96, s96, 0x19000
    s_cmp_eq_u32 s60, 0
    s_cselect_b32 s96, s96, 0x7f000000
    v_mov_b32 v94, s34
    v_mul_u32_u24 v95, 1536, v1
    s_mov_b32 exec_hi, 0
    s_mov_b32 exec_lo, 0xffffffff
    buffer_store_dword v94, v95, s[36:39], s96 offen sc1
    s_mov_b64 exec, -1
    s_branch F_g1w
F_agg:
    s_add_u32 s73, s71, 80
    s_waitcnt vmcnt(0)
    s_barrier
    s_lshl_b32 s96, s73, 2
    s_add_u32 s96, s96, 0x19000
    s_cmp_eq_u32 s60, 0
    s_cselect_b32 s96, s96, 0x7f000000
    v_mov_b32 v94, s34
    v_mul_u32_u24 v95, 1536, v1
    s_mov_b32 exec_hi, 0
    s_mov_b32 exec_lo, 0xffffffff
    buffer_store_dword v94, v95, s[36:39], s96 offen sc1
    s_mov_b64 exec, -1
    s_cmp_lt_u32 s71, 72
    s_cbranch_scc0 F_g1w
    s_sub_u32 s71, s71, 56
    v_add_u32 v92, 80, v0
    v_lshlrev_b32 v92, 2, v92
    v_cmp_gt_u32 vcc, 80, v0
    s_nop 1
    s_and_saveexec_b64 s[56:57], vcc
    s_cbranch_execz Lg9
    s_lshr_b32 s96, s2, 3
    s_xor_b32 s96, s96, s2
    s_and_b32 s96, s96, 31
    s_mul_i32 s96, s96, 1536
    s_add_u32 s96, s96, 0x19000
    s_mov_b32 s97, 0
Lpoll10:
    v_mov_b32 v93, 0
    buffer_atomic_or v93, v92, s[36:39], s96 offen sc0 sc1
    s_add_u32 s97, s97, 1
    s_cmp_gt_u32 s97, 0x40000
    s_cbranch_scc1 Lpoll10_x
    s_waitcnt vmcnt(0)
    v_cmp_ne_u32 vcc, s34, v93
    s_nop 4
    s_cbranch_vccnz Lpoll10
Lpoll10_x:
    s_waitcnt vmcnt(0)
Lg9:
    s_mov_b64 exec, -1
    s_waitcnt vmcnt(0)
    s_barrier
    v_min_u32 v4, 55, v1
    v_cmp_le_u32 vcc, 28, v4
    v_mov_b32 v5, 6720
    s_nop 0
    v_cndmask_b32 v5, 0, v5, vcc
    v_lshl_add_u32 v5, v4, 4, v5
    v_lshlrev_b32 v6, 4, v4
    v_mov_b32 v7, 0xbfb8aa3b
    v_cndmask_b32 v7, 1.0, v7, vcc
    s_mul_i32 s74, s60, 286720
    s_mul_i32 s75, s71, 448
    s_add_u32 s74, s74, s75
    s_add_u32 s74, s74, 0xe80000
    buffer_load_dwordx4 v[64:67], v5, s[36:39], s74 offen sc1
    s_add_u32 s74, s74, 14336
    buffer_load_dwordx4 v[68:71], v5, s[36:39], s74 offen sc1
    s_add_u32 s74, s74, 14336
    buffer_load_dwordx4 v[72:75], v5, s[36:39], s74 offen sc1
    s_add_u32 s74, s74, 14336
    buffer_load_dwordx4 v[76:79], v5, s[36:39], s74 offen sc1
    s_add_u32 s74, s74, 14336
    buffer_load_dwordx4 v[80:83], v5, s[36:39], s74 offen sc1
    s_add_u32 s74, s74, 14336
    buffer_load_dwordx4 v[84:87], v5, s[36:39], s74 offen sc1
    s_add_u32 s74, s74, 14336
    buffer_load_dwordx4 v[88:91], v5, s[36:39], s74 offen sc1
    s_add_u32 s74, s74, 14336
    buffer_load_dwordx4 v[92:95], v5, s[36:39], s74 offen sc1
    s_add_u32 s74, s74, 14336
    buffer_load_dwordx4 v[96:99], v5, s[36:39], s74 offen sc1
    s_add_u32 s74, s74, 14336
    buffer_load_dwordx4 v[100:103], v5, s[36:39], s74 offen sc1
    s_add_u32 s74, s74, 14336
    buffer_load_dwordx4 v[104:107], v5, s[36:39], s74 offen sc1
    s_add_u32 s74, s74, 14336
    buffer_load_dwordx4 v[108:111], v5, s[36:39], s74 offen sc1
    s_add_u32 s74, s74, 14336
    buffer_load_dwordx4 v[112:115], v5, s[36:39], s74 offen sc1
    s_add_u32 s74, s74, 14336
    buffer_load_dwordx4 v[116:119], v5, s[36:39], s74 offen sc1
    s_add_u32 s74, s74, 14336
    buffer_load_dwordx4 v[120:123], v5, s[36:39], s74 offen sc1
    s_add_u32 s74, s74, 14336
    buffer_load_dwordx4 v[124:127], v5, s[36:39], s74 offen sc1
    s_add_u32 s74, s74, 14336
    buffer_load_dwordx4 v[128:131], v5, s[36:39], s74 offen sc1
    s_add_u32 s74, s74, 14336
    buffer_load_dwordx4 v[132:135], v5, s[36:39], s74 offen sc1
    s_add_u32 s74, s74, 14336
    buffer_load_dwordx4 v[136:139], v5, s[36:39], s74 offen sc1
    s_add_u32 s74, s74, 14336
    buffer_load_dwordx4 v[140:143], v5, s[36:39], s74 offen sc1
    s_waitcnt vmcnt(18)
    v_pk_add_f32 v[64:65], v[64:65], v[68:69]
    v_pk_add_f32 v[66:67], v[66:67], v[70:71]
    s_waitcnt vmcnt(17)
    v_pk_add_f32 v[64:65], v[64:65], v[72:73]
    v_pk_add_f32 v[66:67], v[66:67], v[74:75]
    s_waitcnt vmcnt(16)
    v_pk_add_f32 v[64:65], v[64:65], v[76:77]
    v_pk_add_f32 v[66:67], v[66:67], v[78:79]
    s_waitcnt vmcnt(15)
    v_pk_add_f32 v[64:65], v[64:65], v[80:81]
    v_pk_add_f32 v[66:67], v[66:67], v[82:83]
    s_waitcnt vmcnt(14)
    v_pk_add_f32 v[64:65], v[64:65], v[84:85]
    v_pk_add_f32 v[66:67], v[66:67], v[86:87]
    s_waitcnt vmcnt(13)
    v_pk_add_f32 v[64:65], v[64:65], v[88:89]
    v_pk_add_f32 v[66:67], v[66:67], v[90:91]
    s_waitcnt vmcnt(12)
    v_pk_add_f32 v[64:65], v[64:65], v[92:93]
    v_pk_add_f32 v[66:67], v[66:67], v[94:95]
    s_waitcnt vmcnt(11)
    v_pk_add_f32 v[64:65], v[64:65], v[96:97]
    v_pk_add_f32 v[66:67], v[66:67], v[98:99]
    s_waitcnt vmcnt(10)
    v_pk_add_f32 v[64:65], v[64:65], v[100:101]
    v_pk_add_f32 v[66:67], v[66:67], v[102:103]
    s_waitcnt vmcnt(9)
    v_pk_add_f32 v[64:65], v[64:65], v[104:105]
    v_pk_add_f32 v[66:67], v[66:67], v[106:107]
    s_waitcnt vmcnt(8)
    v_pk_add_f32 v[64:65], v[64:65], v[108:109]
    v_pk_add_f32 v[66:67], v[66:67], v[110:111]
    s_waitcnt vmcnt(7)
    v_pk_add_f32 v[64:65], v[64:65], v[112:113]
    v_pk_add_f32 v[66:67], v[66:67], v[114:115]
    s_waitcnt vmcnt(6)
    v_pk_add_f32 v[64:65], v[64:65], v[116:117]
    v_pk_add_f32 v[66:67], v[66:67], v[118:119]
    s_waitcnt vmcnt(5)
    v_pk_add_f32 v[64:65], v[64:65], v[120:121]
    v_pk_add_f32 v[66:67], v[66:67], v[122:123]
    s_waitcnt vmcnt(4)
    v_pk_add_f32 v[64:65], v[64:65], v[124:125]
    v_pk_add_f32 v[66:67], v[66:67], v[126:127]
    s_waitcnt vmcnt(3)
    v_pk_add_f32 v[64:65], v[64:65], v[128:129]
    v_pk_add_f32 v[66:67], v[66:67], v[130:131]
    s_waitcnt vmcnt(2)
    v_pk_add_f32 v[64:65], v[64:65], v[132:133]
    v_pk_add_f32 v[66:67], v[66:67], v[134:135]
    s_waitcnt vmcnt(1)
    v_pk_add_f32 v[64:65], v[64:65], v[136:137]
    v_pk_add_f32 v[66:67], v[66:67], v[138:139]
    s_waitcnt vmcnt(0)
    v_pk_add_f32 v[64:65], v[64:65], v[140:141]
    v_pk_add_f32 v[66:67], v[66:67], v[142:143]
    v_lshlrev_b32 v8, 4, v0
    v_lshlrev_b32 v9, 4, v1
    ds_write_b128 v8, v[64:67]
    s_waitcnt lgkmcnt(0)
    s_barrier
    ds_read_b128 v[64:67], v9 offset:0
    ds_read_b128 v[68:71], v9 offset:1024
    ds_read_b128 v[72:75], v9 offset:2048
    ds_read_b128 v[76:79], v9 offset:3072
    s_waitcnt lgkmcnt(2)
    v_pk_add_f32 v[64:65], v[64:65], v[68:69]
    s_waitcnt lgkmcnt(0)
    v_pk_add_f32 v[72:73], v[72:73], v[76:77]
    v_pk_add_f32 v[66:67], v[66:67], v[70:71]
    v_pk_add_f32 v[74:75], v[74:75], v[78:79]
    v_pk_add_f32 v[64:65], v[64:65], v[72:73]
    v_pk_add_f32 v[66:67], v[66:67], v[74:75]
    v_mul_f32 v64, v64, v7
    v_mul_f32 v65, v65, v7
    v_mul_f32 v66, v66, v7
    v_mul_f32 v67, v67, v7
    s_lshl_b32 s74, s71, 10
    s_add_u32 s74, s74, 0x50000
    s_cmp_eq_u32 s60, 0
    s_cselect_b32 s74, s74, 0x7f000000
    buffer_store_dwordx4 v[64:67], v6, s[36:39], s74 offen sc1
    s_waitcnt vmcnt(0)
    s_lshl_b32 s96, s71, 9
    s_add_u32 s96, s96, 0x32180
    s_cmp_eq_u32 s60, 0
    s_cselect_b32 s96, s96, 0x7f000000
    v_mov_b32 v92, s34
    v_mov_b32 v93, 0
    s_mov_b64 exec, 1
    buffer_store_dword v92, v93, s[36:39], s96 offen sc1
    s_mov_b64 exec, -1
    s_barrier
F_g1w:
    v_and_b32 v92, 1, v1
    v_lshlrev_b32 v92, 7, v92
    v_lshlrev_b32 v3, 4, v1
    buffer_load_dword v93, v92, s[36:39], s89 offen offset:0 sc1
    s_waitcnt vmcnt(0)
    v_cmp_ne_u32 s[56:57], s34, v93
    s_nop 1
    s_cmp_lg_u64 s[56:57], 0
    s_cbranch_scc0 F_h1
    s_mov_b32 s97, 0
F_h1_l:
    s_sleep 1
    buffer_load_dword v93, v92, s[36:39], s89 offen offset:0 sc1
    s_add_u32 s97, s97, 1
    s_waitcnt vmcnt(0)
    v_cmp_ne_u32 s[56:57], s34, v93
    s_nop 1
    s_cmp_lg_u64 s[56:57], 0
    s_cbranch_scc0 F_h1
    s_cmp_lt_u32 s97, 0x40000
    s_cbranch_scc1 F_h1_l
F_h1:
    s_mul_i32 s3, s93, 143360
    s_add_u32 s3, s3, 0x900000
    s_mul_i32 s63, s60, 20480
    s_add_u32 s63, s63, s3
    s_mul_i32 s66, s60, 33792
    s_add_u32 m0, s66, 13312
    s_nop 0
    buffer_load_dwordx4 v3, s[36:39], s63 offen offset:0 sc1 lds
    buffer_load_dwordx4 v3, s[36:39], s63 offen offset:1024 sc1 lds
    buffer_load_dwordx4 v3, s[36:39], s63 offen offset:2048 sc1 lds
    buffer_load_dwordx4 v3, s[36:39], s63 offen offset:3072 sc1 lds
    s_add_u32 m0, m0, 4096
    s_add_u32 s63, s63, 4096
    buffer_load_dwordx4 v3, s[36:39], s63 offen offset:0 sc1 lds
    buffer_load_dwordx4 v3, s[36:39], s63 offen offset:1024 sc1 lds
    buffer_load_dwordx4 v3, s[36:39], s63 offen offset:2048 sc1 lds
    buffer_load_dwordx4 v3, s[36:39], s63 offen offset:3072 sc1 lds
    s_add_u32 m0, m0, 4096
    s_add_u32 s63, s63, 4096
    buffer_load_dwordx4 v3, s[36:39], s63 offen offset:0 sc1 lds
    buffer_load_dwordx4 v3, s[36:39], s63 offen offset:1024 sc1 lds
    buffer_load_dwordx4 v3, s[36:39], s63 offen offset:2048 sc1 lds
    buffer_load_dwordx4 v3, s[36:39], s63 offen offset:3072 sc1 lds
    s_add_u32 m0, m0, 4096
    s_add_u32 s63, s63, 4096
    buffer_load_dwordx4 v3, s[36:39], s63 offen offset:0 sc1 lds
    buffer_load_dwordx4 v3, s[36:39], s63 offen offset:1024 sc1 lds
    buffer_load_dwordx4 v3, s[36:39], s63 offen offset:2048 sc1 lds
    buffer_load_dwordx4 v3, s[36:39], s63 offen offset:3072 sc1 lds
    s_add_u32 m0, m0, 4096
    s_add_u32 s63, s63, 4096
    buffer_load_dwordx4 v3, s[36:39], s63 offen offset:0 sc1 lds
    buffer_load_dwordx4 v3, s[36:39], s63 offen offset:1024 sc1 lds
    buffer_load_dwordx4 v3, s[36:39], s63 offen offset:2048 sc1 lds
    buffer_load_dwordx4 v3, s[36:39], s63 offen offset:3072 sc1 lds
    s_lshl_b32 s63, s60, 11
    s_add_u32 m0, s63, 135168
    s_add_u32 s63, s63, s3
    s_add_u32 s63, s63, 81920
    buffer_load_dwordx4 v3, s[36:39], s63 offen offset:0 sc1 lds
    buffer_load_dwordx4 v3, s[36:39], s63 offen offset:1024 sc1 lds
    s_mul_i32 s63, s60, 33792
    s_add_u32 m0, s63, 0
    s_mul_i32 s63, s60, 4096
    s_add_u32 s63, s63, s3
    s_add_u32 s63, s63, 90112
    s_waitcnt vmcnt(0)
    s_barrier
    s_branch F_g1x
F_conv:
    s_waitcnt vmcnt(7)
    v_lshlrev_b32 v240, 16, v240
    v_mov_b32 v245, s34
    v_mov_b32 v60, 0
    v_mov_b32 v61, 0
    s_mul_i32 s3, s93, 143360
    s_add_u32 s3, s3, 0x900000
    s_mul_i32 s63, s60, 20480
    s_add_u32 s63, s63, s3
    s_mul_i32 s66, s60, 33792
    s_add_u32 m0, s66, 13312
    v_lshlrev_b32 v106, 16, v106
    v_mul_f32 v106, 0x3fb8aa3b, v106
    v_exp_f32 v106, v106
    s_mul_i32 s75, s60, 33792
    v_lshlrev_b32 v108, 3, v1
    v_add_u32 v108, s75, v108
    v_add_u32 v107, 16896, v108
    v_cvt_pk_bf16_f32 v106, v106, v106
    v_lshlrev_b32 v106, 16, v106
    v_lshlrev_b32 v134, 16, v102
    v_and_b32 v164, 0xffff0000, v102
    v_mul_f32 v134, 0x3fb8aa3b, v134
    v_mul_f32 v164, 0x3fb8aa3b, v164
    v_exp_f32 v134, v134
    v_exp_f32 v164, v164
    v_lshlrev_b32 v135, 16, v103
    v_and_b32 v165, 0xffff0000, v103
    v_cvt_pk_bf16_f32 v134, v134, v134
    v_cvt_pk_bf16_f32 v164, v164, v164
    v_mul_f32 v135, v135, v106
    v_mul_f32 v165, v165, v106
    v_lshlrev_b32 v134, 16, v134
    v_lshlrev_b32 v164, 16, v164
    v_mul_f32 v135, 0.15915494, v135
    v_mul_f32 v165, 0.15915494, v165
    v_mul_f32 v134, v134, v106
    v_mul_f32 v164, v164, v106
    v_lshlrev_b32 v120, 16, v104
    v_and_b32 v150, 0xffff0000, v104
    v_mul_f32 v134, 0xbfb8aa3b, v134
    v_mul_f32 v164, 0xbfb8aa3b, v164
    v_lshlrev_b32 v121, 16, v105
    v_and_b32 v151, 0xffff0000, v105
    v_mul_f32 v137, 0x41000000, v135
    v_mul_f32 v167, 0x41000000, v165
    v_mul_f32 v136, 0x41000000, v134
    v_mul_f32 v166, 0x41000000, v164
    v_rndne_f32 v118, v137
    v_rndne_f32 v148, v167
    v_exp_f32 v136, v136
    v_exp_f32 v166, v166
    v_sub_f32 v137, v137, v118
    v_sub_f32 v167, v167, v148
    v_cos_f32 v112, v137
    v_cos_f32 v142, v167
    v_sin_f32 v113, v137
    v_sin_f32 v143, v167
    v_pk_mul_f32 v[112:113], v[112:113], v[136:137] op_sel_hi:[1,0]
    v_pk_mul_f32 v[142:143], v[142:143], v[166:167] op_sel_hi:[1,0]
    v_rndne_f32 v118, v135
    v_rndne_f32 v148, v165
    v_exp_f32 v136, v134
    v_exp_f32 v166, v164
    v_sub_f32 v137, v135, v118
    v_sub_f32 v167, v165, v148
    v_cos_f32 v110, v137
    v_cos_f32 v140, v167
    v_sin_f32 v111, v137
    v_sin_f32 v141, v167
    v_pk_mul_f32 v[110:111], v[110:111], v[136:137] op_sel_hi:[1,0]
    v_pk_mul_f32 v[140:141], v[140:141], v[166:167] op_sel_hi:[1,0]
    v_mul_f32 v137, 0x43800000, v135
    v_mul_f32 v167, 0x43800000, v165
    v_mul_f32 v136, 0x43800000, v134
    v_mul_f32 v166, 0x43800000, v164
    v_rndne_f32 v118, v137
    v_rndne_f32 v148, v167
    v_exp_f32 v136, v136
    v_exp_f32 v166, v166
    v_sub_f32 v137, v137, v118
    v_sub_f32 v167, v167, v148
    v_cos_f32 v114, v137
    v_cos_f32 v144, v167
    v_sin_f32 v115, v137
    v_sin_f32 v145, v167
    v_pk_mul_f32 v[114:115], v[114:115], v[136:137] op_sel_hi:[1,0]
    v_pk_mul_f32 v[144:145], v[144:145], v[166:167] op_sel_hi:[1,0]
    v_mov_b32 v168, 0x3f80
    v_mov_b32 v169, 0x3f80
    v_cvt_pk_bf16_f32 v176, v120, -v121
    v_cvt_pk_bf16_f32 v177, v150, -v151
    v_cvt_pk_bf16_f32 v170, v112, v113
    v_cvt_pk_bf16_f32 v171, v142, v143
    ds_write2_b64 v108, v[168:169], v[170:171] offset0:0 offset1:66
    v_pk_mul_f32 v[132:133], v[120:121], v[110:111] op_sel_hi:[1,0]
    v_pk_mul_f32 v[162:163], v[150:151], v[140:141] op_sel_hi:[1,0]
    v_pk_fma_f32 v[130:131], v[120:121], v[110:111], v[132:133] op_sel:[1,1,0] op_sel_hi:[0,1,1] neg_lo:[1,0,0]
    v_pk_fma_f32 v[160:161], v[150:151], v[140:141], v[162:163] op_sel:[1,1,0] op_sel_hi:[0,1,1] neg_lo:[1,0,0]
    v_cvt_pk_bf16_f32 v178, v130, -v131
    v_cvt_pk_bf16_f32 v179, v160, -v161
    ds_write2_b64 v107, v[176:177], v[178:179] offset0:0 offset1:66
    v_pk_mul_f32 v[118:119], v[112:113], v[112:113] op_sel_hi:[1,0]
    v_pk_mul_f32 v[148:149], v[142:143], v[142:143] op_sel_hi:[1,0]
    v_pk_fma_f32 v[116:117], v[112:113], v[112:113], v[118:119] op_sel:[1,1,0] op_sel_hi:[0,1,1] neg_lo:[1,0,0]
    v_pk_fma_f32 v[146:147], v[142:143], v[142:143], v[148:149] op_sel:[1,1,0] op_sel_hi:[0,1,1] neg_lo:[1,0,0]
    v_cvt_pk_bf16_f32 v172, v116, v117
    v_cvt_pk_bf16_f32 v173, v146, v147
    v_pk_mul_f32 v[132:133], v[130:131], v[110:111] op_sel_hi:[1,0]
    v_pk_mul_f32 v[162:163], v[160:161], v[140:141] op_sel_hi:[1,0]
    v_pk_fma_f32 v[122:123], v[130:131], v[110:111], v[132:133] op_sel:[1,1,0] op_sel_hi:[0,1,1] neg_lo:[1,0,0]
    v_pk_fma_f32 v[152:153], v[160:161], v[140:141], v[162:163] op_sel:[1,1,0] op_sel_hi:[0,1,1] neg_lo:[1,0,0]
    v_cvt_pk_bf16_f32 v180, v122, -v123
    v_cvt_pk_bf16_f32 v181, v152, -v153
    v_pk_mul_f32 v[118:119], v[116:117], v[112:113] op_sel_hi:[1,0]
    v_pk_mul_f32 v[148:149], v[146:147], v[142:143] op_sel_hi:[1,0]
    v_pk_fma_f32 v[116:117], v[116:117], v[112:113], v[118:119] op_sel:[1,1,0] op_sel_hi:[0,1,1] neg_lo:[1,0,0]
    v_pk_fma_f32 v[146:147], v[146:147], v[142:143], v[148:149] op_sel:[1,1,0] op_sel_hi:[0,1,1] neg_lo:[1,0,0]
    v_cvt_pk_bf16_f32 v174, v116, v117
    v_cvt_pk_bf16_f32 v175, v146, v147
    ds_write2_b64 v108, v[172:173], v[174:175] offset0:132 offset1:198
    v_add_u32 v108, 2112, v108
    v_pk_mul_f32 v[132:133], v[122:123], v[110:111] op_sel_hi:[1,0]
    v_pk_mul_f32 v[162:163], v[152:153], v[140:141] op_sel_hi:[1,0]
    v_pk_fma_f32 v[130:131], v[122:123], v[110:111], v[132:133] op_sel:[1,1,0] op_sel_hi:[0,1,1] neg_lo:[1,0,0]
    v_pk_fma_f32 v[160:161], v[152:153], v[140:141], v[162:163] op_sel:[1,1,0] op_sel_hi:[0,1,1] neg_lo:[1,0,0]
    v_cvt_pk_bf16_f32 v182, v130, -v131
    v_cvt_pk_bf16_f32 v183, v160, -v161
    ds_write2_b64 v107, v[180:181], v[182:183] offset0:132 offset1:198
    v_add_u32 v107, 2112, v107
    v_pk_mul_f32 v[118:119], v[116:117], v[112:113] op_sel_hi:[1,0]
    s_waitcnt vmcnt(0)
    s_barrier
    s_lshl_b32 s96, s2, 2
    s_add_u32 s96, s96, 0x1000
    s_cmp_eq_u32 s60, 0
    s_cselect_b32 s96, s96, 0x7f000000
    v_mov_b32 v94, s34
    v_mul_u32_u24 v95, 1536, v1
    s_mov_b32 exec_hi, 0
    s_mov_b32 exec_lo, 0xffffffff
    buffer_store_dword v94, v95, s[36:39], s96 offen sc1
    s_mov_b64 exec, -1
    v_pk_mul_f32 v[148:149], v[146:147], v[142:143] op_sel_hi:[1,0]
    v_pk_fma_f32 v[116:117], v[116:117], v[112:113], v[118:119] op_sel:[1,1,0] op_sel_hi:[0,1,1] neg_lo:[1,0,0]
    v_pk_fma_f32 v[146:147], v[146:147], v[142:143], v[148:149] op_sel:[1,1,0] op_sel_hi:[0,1,1] neg_lo:[1,0,0]
    v_cvt_pk_bf16_f32 v168, v116, v117
    v_cvt_pk_bf16_f32 v169, v146, v147
    v_pk_mul_f32 v[132:133], v[130:131], v[110:111] op_sel_hi:[1,0]
    v_pk_mul_f32 v[162:163], v[160:161], v[140:141] op_sel_hi:[1,0]
    v_pk_fma_f32 v[124:125], v[130:131], v[110:111], v[132:133] op_sel:[1,1,0] op_sel_hi:[0,1,1] neg_lo:[1,0,0]
    v_pk_fma_f32 v[154:155], v[160:161], v[140:141], v[162:163] op_sel:[1,1,0] op_sel_hi:[0,1,1] neg_lo:[1,0,0]
    v_cvt_pk_bf16_f32 v176, v124, -v125
    v_cvt_pk_bf16_f32 v177, v154, -v155
    v_pk_mul_f32 v[118:119], v[116:117], v[112:113] op_sel_hi:[1,0]
    v_pk_mul_f32 v[148:149], v[146:147], v[142:143] op_sel_hi:[1,0]
    v_pk_fma_f32 v[116:117], v[116:117], v[112:113], v[118:119] op_sel:[1,1,0] op_sel_hi:[0,1,1] neg_lo:[1,0,0]
    v_pk_fma_f32 v[146:147], v[146:147], v[142:143], v[148:149] op_sel:[1,1,0] op_sel_hi:[0,1,1] neg_lo:[1,0,0]
    v_cvt_pk_bf16_f32 v170, v116, v117
    v_cvt_pk_bf16_f32 v171, v146, v147
    ds_write2_b64 v108, v[168:169], v[170:171] offset0:0 offset1:66
    v_pk_mul_f32 v[132:133], v[124:125], v[110:111] op_sel_hi:[1,0]
    v_pk_mul_f32 v[162:163], v[154:155], v[140:141] op_sel_hi:[1,0]
    v_pk_fma_f32 v[130:131], v[124:125], v[110:111], v[132:133] op_sel:[1,1,0] op_sel_hi:[0,1,1] neg_lo:[1,0,0]
    v_pk_fma_f32 v[160:161], v[154:155], v[140:141], v[162:163] op_sel:[1,1,0] op_sel_hi:[0,1,1] neg_lo:[1,0,0]
    v_cvt_pk_bf16_f32 v178, v130, -v131
    v_cvt_pk_bf16_f32 v179, v160, -v161
    ds_write2_b64 v107, v[176:177], v[178:179] offset0:0 offset1:66
    v_pk_mul_f32 v[118:119], v[116:117], v[112:113] op_sel_hi:[1,0]
    v_pk_mul_f32 v[148:149], v[146:147], v[142:143] op_sel_hi:[1,0]
    v_pk_fma_f32 v[116:117], v[116:117], v[112:113], v[118:119] op_sel:[1,1,0] op_sel_hi:[0,1,1] neg_lo:[1,0,0]
    v_pk_fma_f32 v[146:147], v[146:147], v[142:143], v[148:149] op_sel:[1,1,0] op_sel_hi:[0,1,1] neg_lo:[1,0,0]
    v_cvt_pk_bf16_f32 v172, v116, v117
    v_cvt_pk_bf16_f32 v173, v146, v147
    v_pk_mul_f32 v[132:133], v[130:131], v[110:111] op_sel_hi:[1,0]
    v_pk_mul_f32 v[162:163], v[160:161], v[140:141] op_sel_hi:[1,0]
    v_pk_fma_f32 v[126:127], v[130:131], v[110:111], v[132:133] op_sel:[1,1,0] op_sel_hi:[0,1,1] neg_lo:[1,0,0]
    v_pk_fma_f32 v[156:157], v[160:161], v[140:141], v[162:163] op_sel:[1,1,0] op_sel_hi:[0,1,1] neg_lo:[1,0,0]
    v_cvt_pk_bf16_f32 v180, v126, -v127
    v_cvt_pk_bf16_f32 v181, v156, -v157
    v_pk_mul_f32 v[118:119], v[116:117], v[112:113] op_sel_hi:[1,0]
    v_pk_mul_f32 v[148:149], v[146:147], v[142:143] op_sel_hi:[1,0]
    v_pk_fma_f32 v[116:117], v[116:117], v[112:113], v[118:119] op_sel:[1,1,0] op_sel_hi:[0,1,1] neg_lo:[1,0,0]
    v_pk_fma_f32 v[146:147], v[146:147], v[142:143], v[148:149] op_sel:[1,1,0] op_sel_hi:[0,1,1] neg_lo:[1,0,0]
    v_cvt_pk_bf16_f32 v174, v116, v117
    v_cvt_pk_bf16_f32 v175, v146, v147
    ds_write2_b64 v108, v[172:173], v[174:175] offset0:132 offset1:198
    v_add_u32 v108, 2112, v108
    v_pk_mul_f32 v[132:133], v[126:127], v[110:111] op_sel_hi:[1,0]
    v_pk_mul_f32 v[162:163], v[156:157], v[140:141] op_sel_hi:[1,0]
    v_pk_fma_f32 v[130:131], v[126:127], v[110:111], v[132:133] op_sel:[1,1,0] op_sel_hi:[0,1,1] neg_lo:[1,0,0]
    v_pk_fma_f32 v[160:161], v[156:157], v[140:141], v[162:163] op_sel:[1,1,0] op_sel_hi:[0,1,1] neg_lo:[1,0,0]
    v_cvt_pk_bf16_f32 v182, v130, -v131
    v_cvt_pk_bf16_f32 v183, v160, -v161
    ds_write2_b64 v107, v[180:181], v[182:183] offset0:132 offset1:198
    v_add_u32 v107, 2112, v107
    v_pk_mul_f32 v[118:119], v[116:117], v[112:113] op_sel_hi:[1,0]
    v_pk_mul_f32 v[148:149], v[146:147], v[142:143] op_sel_hi:[1,0]
    v_pk_fma_f32 v[116:117], v[116:117], v[112:113], v[118:119] op_sel:[1,1,0] op_sel_hi:[0,1,1] neg_lo:[1,0,0]
    v_pk_fma_f32 v[146:147], v[146:147], v[142:143], v[148:149] op_sel:[1,1,0] op_sel_hi:[0,1,1] neg_lo:[1,0,0]
    v_cvt_pk_bf16_f32 v168, v116, v117
    v_cvt_pk_bf16_f32 v169, v146, v147
    v_pk_mul_f32 v[132:133], v[130:131], v[110:111] op_sel_hi:[1,0]
    v_pk_mul_f32 v[162:163], v[160:161], v[140:141] op_sel_hi:[1,0]
    v_pk_fma_f32 v[128:129], v[130:131], v[110:111], v[132:133] op_sel:[1,1,0] op_sel_hi:[0,1,1] neg_lo:[1,0,0]
    v_pk_fma_f32 v[158:159], v[160:161], v[140:141], v[162:163] op_sel:[1,1,0] op_sel_hi:[0,1,1] neg_lo:[1,0,0]
    v_pk_mul_f32 v[118:119], v[116:117], v[112:113] op_sel_hi:[1,0]
    v_pk_mul_f32 v[148:149], v[146:147], v[142:143] op_sel_hi:[1,0]
    v_pk_fma_f32 v[116:117], v[116:117], v[112:113], v[118:119] op_sel:[1,1,0] op_sel_hi:[0,1,1] neg_lo:[1,0,0]
    v_pk_fma_f32 v[146:147], v[146:147], v[142:143], v[148:149] op_sel:[1,1,0] op_sel_hi:[0,1,1] neg_lo:[1,0,0]
    v_cvt_pk_bf16_f32 v170, v116, v117
    v_cvt_pk_bf16_f32 v171, v146, v147
    ds_write2_b64 v108, v[168:169], v[170:171] offset0:0 offset1:66
    v_pk_mul_f32 v[132:133], v[120:121], v[114:115] op_sel_hi:[1,0]
    v_pk_mul_f32 v[162:163], v[150:151], v[144:145] op_sel_hi:[1,0]
    v_pk_fma_f32 v[120:121], v[120:121], v[114:115], v[132:133] op_sel:[1,1,0] op_sel_hi:[0,1,1] neg_lo:[1,0,0]
    v_pk_fma_f32 v[150:151], v[150:151], v[144:145], v[162:163] op_sel:[1,1,0] op_sel_hi:[0,1,1] neg_lo:[1,0,0]
    v_cvt_pk_bf16_f32 v176, v120, -v121
    v_cvt_pk_bf16_f32 v177, v150, -v151
    v_pk_mul_f32 v[118:119], v[116:117], v[112:113] op_sel_hi:[1,0]
    v_pk_mul_f32 v[148:149], v[146:147], v[142:143] op_sel_hi:[1,0]
    v_pk_fma_f32 v[116:117], v[116:117], v[112:113], v[118:119] op_sel:[1,1,0] op_sel_hi:[0,1,1] neg_lo:[1,0,0]
    v_pk_fma_f32 v[146:147], v[146:147], v[142:143], v[148:149] op_sel:[1,1,0] op_sel_hi:[0,1,1] neg_lo:[1,0,0]
    v_cvt_pk_bf16_f32 v172, v116, v117
    v_cvt_pk_bf16_f32 v173, v146, v147
    v_pk_mul_f32 v[132:133], v[122:123], v[114:115] op_sel_hi:[1,0]
    v_pk_mul_f32 v[162:163], v[152:153], v[144:145] op_sel_hi:[1,0]
    v_pk_fma_f32 v[122:123], v[122:123], v[114:115], v[132:133] op_sel:[1,1,0] op_sel_hi:[0,1,1] neg_lo:[1,0,0]
    v_pk_fma_f32 v[152:153], v[152:153], v[144:145], v[162:163] op_sel:[1,1,0] op_sel_hi:[0,1,1] neg_lo:[1,0,0]
    v_cvt_pk_bf16_f32 v178, v122, -v123
    v_cvt_pk_bf16_f32 v179, v152, -v153
    ds_write2_b64 v107, v[176:177], v[178:179] offset0:0 offset1:66
    v_pk_mul_f32 v[118:119], v[116:117], v[112:113] op_sel_hi:[1,0]
    v_pk_mul_f32 v[148:149], v[146:147], v[142:143] op_sel_hi:[1,0]
    v_pk_fma_f32 v[116:117], v[116:117], v[112:113], v[118:119] op_sel:[1,1,0] op_sel_hi:[0,1,1] neg_lo:[1,0,0]
    v_pk_fma_f32 v[146:147], v[146:147], v[142:143], v[148:149] op_sel:[1,1,0] op_sel_hi:[0,1,1] neg_lo:[1,0,0]
    v_cvt_pk_bf16_f32 v174, v116, v117
    v_cvt_pk_bf16_f32 v175, v146, v147
    ds_write2_b64 v108, v[172:173], v[174:175] offset0:132 offset1:198
    v_add_u32 v108, 2112, v108
    v_pk_mul_f32 v[132:133], v[124:125], v[114:115] op_sel_hi:[1,0]
    v_pk_mul_f32 v[162:163], v[154:155], v[144:145] op_sel_hi:[1,0]
    v_pk_fma_f32 v[124:125], v[124:125], v[114:115], v[132:133] op_sel:[1,1,0] op_sel_hi:[0,1,1] neg_lo:[1,0,0]
    v_pk_fma_f32 v[154:155], v[154:155], v[144:145], v[162:163] op_sel:[1,1,0] op_sel_hi:[0,1,1] neg_lo:[1,0,0]
    v_cvt_pk_bf16_f32 v180, v124, -v125
    v_cvt_pk_bf16_f32 v181, v154, -v155
    v_pk_mul_f32 v[118:119], v[116:117], v[112:113] op_sel_hi:[1,0]
    v_pk_mul_f32 v[148:149], v[146:147], v[142:143] op_sel_hi:[1,0]
    v_pk_fma_f32 v[116:117], v[116:117], v[112:113], v[118:119] op_sel:[1,1,0] op_sel_hi:[0,1,1] neg_lo:[1,0,0]
    v_pk_fma_f32 v[146:147], v[146:147], v[142:143], v[148:149] op_sel:[1,1,0] op_sel_hi:[0,1,1] neg_lo:[1,0,0]
    v_cvt_pk_bf16_f32 v168, v116, v117
    v_cvt_pk_bf16_f32 v169, v146, v147
    v_pk_mul_f32 v[132:133], v[126:127], v[114:115] op_sel_hi:[1,0]
    v_pk_mul_f32 v[162:163], v[156:157], v[144:145] op_sel_hi:[1,0]
    v_pk_fma_f32 v[126:127], v[126:127], v[114:115], v[132:133] op_sel:[1,1,0] op_sel_hi:[0,1,1] neg_lo:[1,0,0]
    v_pk_fma_f32 v[156:157], v[156:157], v[144:145], v[162:163] op_sel:[1,1,0] op_sel_hi:[0,1,1] neg_lo:[1,0,0]
    v_cvt_pk_bf16_f32 v182, v126, -v127
    v_cvt_pk_bf16_f32 v183, v156, -v157
    ds_write2_b64 v107, v[180:181], v[182:183] offset0:132 offset1:198
    v_add_u32 v107, 2112, v107
    v_pk_mul_f32 v[118:119], v[116:117], v[112:113] op_sel_hi:[1,0]
    v_pk_mul_f32 v[148:149], v[146:147], v[142:143] op_sel_hi:[1,0]
    v_pk_fma_f32 v[116:117], v[116:117], v[112:113], v[118:119] op_sel:[1,1,0] op_sel_hi:[0,1,1] neg_lo:[1,0,0]
    v_pk_fma_f32 v[146:147], v[146:147], v[142:143], v[148:149] op_sel:[1,1,0] op_sel_hi:[0,1,1] neg_lo:[1,0,0]
    v_cvt_pk_bf16_f32 v170, v116, v117
    v_cvt_pk_bf16_f32 v171, v146, v147
    ds_write2_b64 v108, v[168:169], v[170:171] offset0:0 offset1:66
    v_pk_mul_f32 v[132:133], v[128:129], v[114:115] op_sel_hi:[1,0]
    v_pk_mul_f32 v[162:163], v[158:159], v[144:145] op_sel_hi:[1,0]
    v_pk_fma_f32 v[128:129], v[128:129], v[114:115], v[132:133] op_sel:[1,1,0] op_sel_hi:[0,1,1] neg_lo:[1,0,0]
    v_pk_fma_f32 v[158:159], v[158:159], v[144:145], v[162:163] op_sel:[1,1,0] op_sel_hi:[0,1,1] neg_lo:[1,0,0]
    v_cvt_pk_bf16_f32 v176, v128, -v129
    v_cvt_pk_bf16_f32 v177, v158, -v159
    v_pk_mul_f32 v[118:119], v[116:117], v[112:113] op_sel_hi:[1,0]
    v_pk_mul_f32 v[148:149], v[146:147], v[142:143] op_sel_hi:[1,0]
    v_pk_fma_f32 v[116:117], v[116:117], v[112:113], v[118:119] op_sel:[1,1,0] op_sel_hi:[0,1,1] neg_lo:[1,0,0]
    v_pk_fma_f32 v[146:147], v[146:147], v[142:143], v[148:149] op_sel:[1,1,0] op_sel_hi:[0,1,1] neg_lo:[1,0,0]
    v_cvt_pk_bf16_f32 v172, v116, v117
    v_cvt_pk_bf16_f32 v173, v146, v147
    v_pk_mul_f32 v[132:133], v[120:121], v[114:115] op_sel_hi:[1,0]
    v_pk_mul_f32 v[162:163], v[150:151], v[144:145] op_sel_hi:[1,0]
    v_pk_fma_f32 v[120:121], v[120:121], v[114:115], v[132:133] op_sel:[1,1,0] op_sel_hi:[0,1,1] neg_lo:[1,0,0]
    v_pk_fma_f32 v[150:151], v[150:151], v[144:145], v[162:163] op_sel:[1,1,0] op_sel_hi:[0,1,1] neg_lo:[1,0,0]
    v_cvt_pk_bf16_f32 v178, v120, -v121
    v_cvt_pk_bf16_f32 v179, v150, -v151
    ds_write2_b64 v107, v[176:177], v[178:179] offset0:0 offset1:66
    v_pk_mul_f32 v[118:119], v[116:117], v[112:113] op_sel_hi:[1,0]
    v_pk_mul_f32 v[148:149], v[146:147], v[142:143] op_sel_hi:[1,0]
    v_pk_fma_f32 v[116:117], v[116:117], v[112:113], v[118:119] op_sel:[1,1,0] op_sel_hi:[0,1,1] neg_lo:[1,0,0]
    v_pk_fma_f32 v[146:147], v[146:147], v[142:143], v[148:149] op_sel:[1,1,0] op_sel_hi:[0,1,1] neg_lo:[1,0,0]
    v_cvt_pk_bf16_f32 v174, v116, v117
    v_cvt_pk_bf16_f32 v175, v146, v147
    ds_write2_b64 v108, v[172:173], v[174:175] offset0:132 offset1:198
    v_add_u32 v108, 2112, v108
    v_pk_mul_f32 v[132:133], v[124:125], v[114:115] op_sel_hi:[1,0]
    v_pk_mul_f32 v[162:163], v[154:155], v[144:145] op_sel_hi:[1,0]
    v_pk_fma_f32 v[124:125], v[124:125], v[114:115], v[132:133] op_sel:[1,1,0] op_sel_hi:[0,1,1] neg_lo:[1,0,0]
    v_pk_fma_f32 v[154:155], v[154:155], v[144:145], v[162:163] op_sel:[1,1,0] op_sel_hi:[0,1,1] neg_lo:[1,0,0]
    v_cvt_pk_bf16_f32 v180, v124, -v125
    v_cvt_pk_bf16_f32 v181, v154, -v155
    v_pk_mul_f32 v[118:119], v[116:117], v[112:113] op_sel_hi:[1,0]
    v_pk_mul_f32 v[148:149], v[146:147], v[142:143] op_sel_hi:[1,0]
    v_pk_fma_f32 v[116:117], v[116:117], v[112:113], v[118:119] op_sel:[1,1,0] op_sel_hi:[0,1,1] neg_lo:[1,0,0]
    v_pk_fma_f32 v[146:147], v[146:147], v[142:143], v[148:149] op_sel:[1,1,0] op_sel_hi:[0,1,1] neg_lo:[1,0,0]
    v_cvt_pk_bf16_f32 v168, v116, v117
    v_cvt_pk_bf16_f32 v169, v146, v147
    v_pk_mul_f32 v[132:133], v[128:129], v[114:115] op_sel_hi:[1,0]
    v_pk_mul_f32 v[162:163], v[158:159], v[144:145] op_sel_hi:[1,0]
    v_pk_fma_f32 v[128:129], v[128:129], v[114:115], v[132:133] op_sel:[1,1,0] op_sel_hi:[0,1,1] neg_lo:[1,0,0]
    v_pk_fma_f32 v[158:159], v[158:159], v[144:145], v[162:163] op_sel:[1,1,0] op_sel_hi:[0,1,1] neg_lo:[1,0,0]
    v_cvt_pk_bf16_f32 v182, v128, -v129
    v_cvt_pk_bf16_f32 v183, v158, -v159
    ds_write2_b64 v107, v[180:181], v[182:183] offset0:132 offset1:198
    v_add_u32 v107, 2112, v107
    v_pk_mul_f32 v[118:119], v[116:117], v[112:113] op_sel_hi:[1,0]
    v_pk_mul_f32 v[148:149], v[146:147], v[142:143] op_sel_hi:[1,0]
    v_pk_fma_f32 v[116:117], v[116:117], v[112:113], v[118:119] op_sel:[1,1,0] op_sel_hi:[0,1,1] neg_lo:[1,0,0]
    v_pk_fma_f32 v[146:147], v[146:147], v[142:143], v[148:149] op_sel:[1,1,0] op_sel_hi:[0,1,1] neg_lo:[1,0,0]
    v_cvt_pk_bf16_f32 v170, v116, v117
    v_cvt_pk_bf16_f32 v171, v146, v147
    ds_write2_b64 v108, v[168:169], v[170:171] offset0:0 offset1:66
    v_pk_mul_f32 v[132:133], v[120:121], v[114:115] op_sel_hi:[1,0]
    v_pk_mul_f32 v[162:163], v[150:151], v[144:145] op_sel_hi:[1,0]
    v_pk_fma_f32 v[120:121], v[120:121], v[114:115], v[132:133] op_sel:[1,1,0] op_sel_hi:[0,1,1] neg_lo:[1,0,0]
    v_pk_fma_f32 v[150:151], v[150:151], v[144:145], v[162:163] op_sel:[1,1,0] op_sel_hi:[0,1,1] neg_lo:[1,0,0]
    v_cvt_pk_bf16_f32 v176, v120, -v121
    v_cvt_pk_bf16_f32 v177, v150, -v151
    v_pk_mul_f32 v[118:119], v[116:117], v[112:113] op_sel_hi:[1,0]
    v_pk_mul_f32 v[148:149], v[146:147], v[142:143] op_sel_hi:[1,0]
    v_pk_fma_f32 v[116:117], v[116:117], v[112:113], v[118:119] op_sel:[1,1,0] op_sel_hi:[0,1,1] neg_lo:[1,0,0]
    v_pk_fma_f32 v[146:147], v[146:147], v[142:143], v[148:149] op_sel:[1,1,0] op_sel_hi:[0,1,1] neg_lo:[1,0,0]
    v_cvt_pk_bf16_f32 v172, v116, v117
    v_cvt_pk_bf16_f32 v173, v146, v147
    v_pk_mul_f32 v[132:133], v[124:125], v[114:115] op_sel_hi:[1,0]
    v_pk_mul_f32 v[162:163], v[154:155], v[144:145] op_sel_hi:[1,0]
    v_pk_fma_f32 v[124:125], v[124:125], v[114:115], v[132:133] op_sel:[1,1,0] op_sel_hi:[0,1,1] neg_lo:[1,0,0]
    v_pk_fma_f32 v[154:155], v[154:155], v[144:145], v[162:163] op_sel:[1,1,0] op_sel_hi:[0,1,1] neg_lo:[1,0,0]
    v_cvt_pk_bf16_f32 v178, v124, -v125
    v_cvt_pk_bf16_f32 v179, v154, -v155
    ds_write2_b64 v107, v[176:177], v[178:179] offset0:0 offset1:66
    v_pk_mul_f32 v[118:119], v[116:117], v[112:113] op_sel_hi:[1,0]
    v_pk_mul_f32 v[148:149], v[146:147], v[142:143] op_sel_hi:[1,0]
    v_pk_fma_f32 v[116:117], v[116:117], v[112:113], v[118:119] op_sel:[1,1,0] op_sel_hi:[0,1,1] neg_lo:[1,0,0]
    v_pk_fma_f32 v[146:147], v[146:147], v[142:143], v[148:149] op_sel:[1,1,0] op_sel_hi:[0,1,1] neg_lo:[1,0,0]
    v_cvt_pk_bf16_f32 v174, v116, v117
    v_cvt_pk_bf16_f32 v175, v146, v147
    ds_write2_b64 v108, v[172:173], v[174:175] offset0:132 offset1:198
    v_add_u32 v108, 2112, v108
    v_pk_mul_f32 v[132:133], v[128:129], v[114:115] op_sel_hi:[1,0]
    v_pk_mul_f32 v[162:163], v[158:159], v[144:145] op_sel_hi:[1,0]
    v_pk_fma_f32 v[128:129], v[128:129], v[114:115], v[132:133] op_sel:[1,1,0] op_sel_hi:[0,1,1] neg_lo:[1,0,0]
    v_pk_fma_f32 v[158:159], v[158:159], v[144:145], v[162:163] op_sel:[1,1,0] op_sel_hi:[0,1,1] neg_lo:[1,0,0]
    v_cvt_pk_bf16_f32 v180, v128, -v129
    v_cvt_pk_bf16_f32 v181, v158, -v159
    v_pk_mul_f32 v[118:119], v[116:117], v[112:113] op_sel_hi:[1,0]
    v_pk_mul_f32 v[148:149], v[146:147], v[142:143] op_sel_hi:[1,0]
    v_pk_fma_f32 v[116:117], v[116:117], v[112:113], v[118:119] op_sel:[1,1,0] op_sel_hi:[0,1,1] neg_lo:[1,0,0]
    v_pk_fma_f32 v[146:147], v[146:147], v[142:143], v[148:149] op_sel:[1,1,0] op_sel_hi:[0,1,1] neg_lo:[1,0,0]
    v_cvt_pk_bf16_f32 v168, v116, v117
    v_cvt_pk_bf16_f32 v169, v146, v147
    v_pk_mul_f32 v[132:133], v[120:121], v[114:115] op_sel_hi:[1,0]
    v_pk_mul_f32 v[162:163], v[150:151], v[144:145] op_sel_hi:[1,0]
    v_pk_fma_f32 v[120:121], v[120:121], v[114:115], v[132:133] op_sel:[1,1,0] op_sel_hi:[0,1,1] neg_lo:[1,0,0]
    v_pk_fma_f32 v[150:151], v[150:151], v[144:145], v[162:163] op_sel:[1,1,0] op_sel_hi:[0,1,1] neg_lo:[1,0,0]
    v_cvt_pk_bf16_f32 v182, v120, -v121
    v_cvt_pk_bf16_f32 v183, v150, -v151
    ds_write2_b64 v107, v[180:181], v[182:183] offset0:132 offset1:198
    v_add_u32 v107, 2112, v107
    v_pk_mul_f32 v[118:119], v[116:117], v[112:113] op_sel_hi:[1,0]
    v_pk_mul_f32 v[148:149], v[146:147], v[142:143] op_sel_hi:[1,0]
    v_pk_fma_f32 v[116:117], v[116:117], v[112:113], v[118:119] op_sel:[1,1,0] op_sel_hi:[0,1,1] neg_lo:[1,0,0]
    v_pk_fma_f32 v[146:147], v[146:147], v[142:143], v[148:149] op_sel:[1,1,0] op_sel_hi:[0,1,1] neg_lo:[1,0,0]
    v_cvt_pk_bf16_f32 v170, v116, v117
    v_cvt_pk_bf16_f32 v171, v146, v147
    ds_write2_b64 v108, v[168:169], v[170:171] offset0:0 offset1:66
    v_pk_mul_f32 v[132:133], v[128:129], v[114:115] op_sel_hi:[1,0]
    v_pk_mul_f32 v[162:163], v[158:159], v[144:145] op_sel_hi:[1,0]
    v_pk_fma_f32 v[128:129], v[128:129], v[114:115], v[132:133] op_sel:[1,1,0] op_sel_hi:[0,1,1] neg_lo:[1,0,0]
    v_pk_fma_f32 v[158:159], v[158:159], v[144:145], v[162:163] op_sel:[1,1,0] op_sel_hi:[0,1,1] neg_lo:[1,0,0]
    v_cvt_pk_bf16_f32 v176, v128, -v129
    v_lshlrev_b32 v94, 2, v0
    v_mov_b32 v95, 0
    s_lshr_b32 s96, s2, 3
    s_xor_b32 s96, s96, s2
    s_and_b32 s96, s96, 31
    s_mul_i32 s96, s96, 1536
    s_add_u32 s96, s96, 0x1000
    buffer_atomic_or v95, v94, s[36:39], s96 offen sc0 sc1
    v_cvt_pk_bf16_f32 v177, v158, -v159
    v_pk_mul_f32 v[118:119], v[116:117], v[112:113] op_sel_hi:[1,0]
    v_pk_mul_f32 v[148:149], v[146:147], v[142:143] op_sel_hi:[1,0]
    v_pk_fma_f32 v[116:117], v[116:117], v[112:113], v[118:119] op_sel:[1,1,0] op_sel_hi:[0,1,1] neg_lo:[1,0,0]
    v_pk_fma_f32 v[146:147], v[146:147], v[142:143], v[148:149] op_sel:[1,1,0] op_sel_hi:[0,1,1] neg_lo:[1,0,0]
    v_cvt_pk_bf16_f32 v172, v116, v117
    v_cvt_pk_bf16_f32 v173, v146, v147
    v_pk_mul_f32 v[132:133], v[120:121], v[114:115] op_sel_hi:[1,0]
    v_pk_mul_f32 v[162:163], v[150:151], v[144:145] op_sel_hi:[1,0]
    v_pk_fma_f32 v[120:121], v[120:121], v[114:115], v[132:133] op_sel:[1,1,0] op_sel_hi:[0,1,1] neg_lo:[1,0,0]
    v_pk_fma_f32 v[150:151], v[150:151], v[144:145], v[162:163] op_sel:[1,1,0] op_sel_hi:[0,1,1] neg_lo:[1,0,0]
    v_cvt_pk_bf16_f32 v178, v120, -v121
    v_cvt_pk_bf16_f32 v179, v150, -v151
    ds_write2_b64 v107, v[176:177], v[178:179] offset0:0 offset1:66
    v_pk_mul_f32 v[118:119], v[116:117], v[112:113] op_sel_hi:[1,0]
    v_pk_mul_f32 v[148:149], v[146:147], v[142:143] op_sel_hi:[1,0]
    v_pk_fma_f32 v[116:117], v[116:117], v[112:113], v[118:119] op_sel:[1,1,0] op_sel_hi:[0,1,1] neg_lo:[1,0,0]
    v_pk_fma_f32 v[146:147], v[146:147], v[142:143], v[148:149] op_sel:[1,1,0] op_sel_hi:[0,1,1] neg_lo:[1,0,0]
    v_cvt_pk_bf16_f32 v174, v116, v117
    v_cvt_pk_bf16_f32 v175, v146, v147
    ds_write2_b64 v108, v[172:173], v[174:175] offset0:132 offset1:198
    v_add_u32 v108, 2112, v108
    v_pk_mul_f32 v[132:133], v[128:129], v[114:115] op_sel_hi:[1,0]
    v_pk_mul_f32 v[162:163], v[158:159], v[144:145] op_sel_hi:[1,0]
    v_pk_fma_f32 v[128:129], v[128:129], v[114:115], v[132:133] op_sel:[1,1,0] op_sel_hi:[0,1,1] neg_lo:[1,0,0]
    v_pk_fma_f32 v[158:159], v[158:159], v[144:145], v[162:163] op_sel:[1,1,0] op_sel_hi:[0,1,1] neg_lo:[1,0,0]
    v_cvt_pk_bf16_f32 v180, v128, -v129
    v_cvt_pk_bf16_f32 v181, v158, -v159
    v_pk_mul_f32 v[118:119], v[116:117], v[112:113] op_sel_hi:[1,0]
    v_pk_mul_f32 v[148:149], v[146:147], v[142:143] op_sel_hi:[1,0]
    v_pk_fma_f32 v[116:117], v[116:117], v[112:113], v[118:119] op_sel:[1,1,0] op_sel_hi:[0,1,1] neg_lo:[1,0,0]
    v_pk_fma_f32 v[146:147], v[146:147], v[142:143], v[148:149] op_sel:[1,1,0] op_sel_hi:[0,1,1] neg_lo:[1,0,0]
    v_cvt_pk_bf16_f32 v168, v116, v117
    v_cvt_pk_bf16_f32 v169, v146, v147
    v_pk_mul_f32 v[132:133], v[120:121], v[114:115] op_sel_hi:[1,0]
    v_pk_mul_f32 v[162:163], v[150:151], v[144:145] op_sel_hi:[1,0]
    v_pk_fma_f32 v[120:121], v[120:121], v[114:115], v[132:133] op_sel:[1,1,0] op_sel_hi:[0,1,1] neg_lo:[1,0,0]
    v_pk_fma_f32 v[150:151], v[150:151], v[144:145], v[162:163] op_sel:[1,1,0] op_sel_hi:[0,1,1] neg_lo:[1,0,0]
    v_cvt_pk_bf16_f32 v182, v120, -v121
    v_cvt_pk_bf16_f32 v183, v150, -v151
    ds_write2_b64 v107, v[180:181], v[182:183] offset0:132 offset1:198
    v_add_u32 v107, 2112, v107
    v_pk_mul_f32 v[118:119], v[116:117], v[112:113] op_sel_hi:[1,0]
    v_pk_mul_f32 v[148:149], v[146:147], v[142:143] op_sel_hi:[1,0]
    v_pk_fma_f32 v[116:117], v[116:117], v[112:113], v[118:119] op_sel:[1,1,0] op_sel_hi:[0,1,1] neg_lo:[1,0,0]
    v_pk_fma_f32 v[146:147], v[146:147], v[142:143], v[148:149] op_sel:[1,1,0] op_sel_hi:[0,1,1] neg_lo:[1,0,0]
    v_cvt_pk_bf16_f32 v170, v116, v117
    v_cvt_pk_bf16_f32 v171, v146, v147
    ds_write2_b64 v108, v[168:169], v[170:171] offset0:0 offset1:66
    v_pk_mul_f32 v[132:133], v[128:129], v[114:115] op_sel_hi:[1,0]
    v_pk_mul_f32 v[162:163], v[158:159], v[144:145] op_sel_hi:[1,0]
    v_pk_fma_f32 v[128:129], v[128:129], v[114:115], v[132:133] op_sel:[1,1,0] op_sel_hi:[0,1,1] neg_lo:[1,0,0]
    v_pk_fma_f32 v[158:159], v[158:159], v[144:145], v[162:163] op_sel:[1,1,0] op_sel_hi:[0,1,1] neg_lo:[1,0,0]
    v_cvt_pk_bf16_f32 v176, v128, -v129
    v_cvt_pk_bf16_f32 v177, v158, -v159
    v_pk_mul_f32 v[118:119], v[116:117], v[112:113] op_sel_hi:[1,0]
    v_pk_mul_f32 v[148:149], v[146:147], v[142:143] op_sel_hi:[1,0]
    v_pk_fma_f32 v[116:117], v[116:117], v[112:113], v[118:119] op_sel:[1,1,0] op_sel_hi:[0,1,1] neg_lo:[1,0,0]
    v_pk_fma_f32 v[146:147], v[146:147], v[142:143], v[148:149] op_sel:[1,1,0] op_sel_hi:[0,1,1] neg_lo:[1,0,0]
    v_cvt_pk_bf16_f32 v172, v116, v117
    v_cvt_pk_bf16_f32 v173, v146, v147
    v_pk_mul_f32 v[132:133], v[120:121], v[114:115] op_sel_hi:[1,0]
    v_pk_mul_f32 v[162:163], v[150:151], v[144:145] op_sel_hi:[1,0]
    v_pk_fma_f32 v[120:121], v[120:121], v[114:115], v[132:133] op_sel:[1,1,0] op_sel_hi:[0,1,1] neg_lo:[1,0,0]
    v_pk_fma_f32 v[150:151], v[150:151], v[144:145], v[162:163] op_sel:[1,1,0] op_sel_hi:[0,1,1] neg_lo:[1,0,0]
    v_cvt_pk_bf16_f32 v178, v120, -v121
    v_cvt_pk_bf16_f32 v179, v150, -v151
    ds_write2_b64 v107, v[176:177], v[178:179] offset0:0 offset1:66
    v_pk_mul_f32 v[118:119], v[116:117], v[112:113] op_sel_hi:[1,0]
    v_pk_mul_f32 v[148:149], v[146:147], v[142:143] op_sel_hi:[1,0]
    v_pk_fma_f32 v[116:117], v[116:117], v[112:113], v[118:119] op_sel:[1,1,0] op_sel_hi:[0,1,1] neg_lo:[1,0,0]
    v_pk_fma_f32 v[146:147], v[146:147], v[142:143], v[148:149] op_sel:[1,1,0] op_sel_hi:[0,1,1] neg_lo:[1,0,0]
    v_cvt_pk_bf16_f32 v174, v116, v117
    v_cvt_pk_bf16_f32 v175, v146, v147
    ds_write2_b64 v108, v[172:173], v[174:175] offset0:132 offset1:198
    v_add_u32 v108, 2112, v108
    v_pk_mul_f32 v[132:133], v[128:129], v[114:115] op_sel_hi:[1,0]
    v_pk_mul_f32 v[162:163], v[158:159], v[144:145] op_sel_hi:[1,0]
    v_pk_fma_f32 v[128:129], v[128:129], v[114:115], v[132:133] op_sel:[1,1,0] op_sel_hi:[0,1,1] neg_lo:[1,0,0]
    v_pk_fma_f32 v[158:159], v[158:159], v[144:145], v[162:163] op_sel:[1,1,0] op_sel_hi:[0,1,1] neg_lo:[1,0,0]
    v_cvt_pk_bf16_f32 v180, v128, -v129
    v_cvt_pk_bf16_f32 v181, v158, -v159
    ds_write_b64 v107, v[180:181] offset:1056
    v_pk_mul_f32 v[118:119], v[116:117], v[112:113] op_sel_hi:[1,0]
    v_pk_mul_f32 v[148:149], v[146:147], v[142:143] op_sel_hi:[1,0]
    v_pk_fma_f32 v[116:117], v[116:117], v[112:113], v[118:119] op_sel:[1,1,0] op_sel_hi:[0,1,1] neg_lo:[1,0,0]
    v_pk_fma_f32 v[146:147], v[146:147], v[142:143], v[148:149] op_sel:[1,1,0] op_sel_hi:[0,1,1] neg_lo:[1,0,0]
    v_cvt_pk_bf16_f32 v168, v116, v117
    v_cvt_pk_bf16_f32 v169, v146, v147
    v_pk_mul_f32 v[118:119], v[116:117], v[112:113] op_sel_hi:[1,0]
    v_pk_mul_f32 v[148:149], v[146:147], v[142:143] op_sel_hi:[1,0]
    v_pk_fma_f32 v[116:117], v[116:117], v[112:113], v[118:119] op_sel:[1,1,0] op_sel_hi:[0,1,1] neg_lo:[1,0,0]
    v_pk_fma_f32 v[146:147], v[146:147], v[142:143], v[148:149] op_sel:[1,1,0] op_sel_hi:[0,1,1] neg_lo:[1,0,0]
    v_cvt_pk_bf16_f32 v170, v116, v117
    v_cvt_pk_bf16_f32 v171, v146, v147
    ds_write2_b64 v108, v[168:169], v[170:171] offset0:0 offset1:66
    v_pk_mul_f32 v[118:119], v[116:117], v[112:113] op_sel_hi:[1,0]
    v_pk_mul_f32 v[148:149], v[146:147], v[142:143] op_sel_hi:[1,0]
    v_pk_fma_f32 v[116:117], v[116:117], v[112:113], v[118:119] op_sel:[1,1,0] op_sel_hi:[0,1,1] neg_lo:[1,0,0]
    v_pk_fma_f32 v[146:147], v[146:147], v[142:143], v[148:149] op_sel:[1,1,0] op_sel_hi:[0,1,1] neg_lo:[1,0,0]
    v_cvt_pk_bf16_f32 v172, v116, v117
    v_cvt_pk_bf16_f32 v173, v146, v147
    v_pk_mul_f32 v[118:119], v[116:117], v[112:113] op_sel_hi:[1,0]
    v_pk_mul_f32 v[148:149], v[146:147], v[142:143] op_sel_hi:[1,0]
    v_pk_fma_f32 v[116:117], v[116:117], v[112:113], v[118:119] op_sel:[1,1,0] op_sel_hi:[0,1,1] neg_lo:[1,0,0]
    v_pk_fma_f32 v[146:147], v[146:147], v[142:143], v[148:149] op_sel:[1,1,0] op_sel_hi:[0,1,1] neg_lo:[1,0,0]
    v_cvt_pk_bf16_f32 v174, v116, v117
    v_cvt_pk_bf16_f32 v175, v146, v147
    ds_write2_b64 v108, v[172:173], v[174:175] offset0:132 offset1:198
    v_add_u32 v108, 2112, v108
    s_waitcnt vmcnt(0)
    v_cmp_ne_u32 vcc, s34, v95
    s_nop 4
    s_cbranch_vccz F_p1ok
    s_mov_b32 s97, 0
Lpoll11:
    v_mov_b32 v95, 0
    buffer_atomic_or v95, v94, s[36:39], s96 offen sc0 sc1
    s_add_u32 s97, s97, 1
    s_cmp_gt_u32 s97, 0x40000
    s_cbranch_scc1 Lpoll11_x
    s_waitcnt vmcnt(0)
    v_cmp_ne_u32 vcc, s34, v95
    s_nop 4
    s_cbranch_vccnz Lpoll11
Lpoll11_x:
    s_waitcnt vmcnt(0)
F_p1ok:
    s_barrier
    buffer_load_dword v7, v227, s[36:39], s85 offen sc1
    v_and_b32 v109, 31, v1
    v_lshrrev_b32 v110, 5, v1
    v_mov_b32 v116, 0x3020100
    s_mov_b32 s76, 0xa090808
    v_writelane_b32 v116, s76, 1
    buffer_load_dwordx4 v[208:211], v216, s[36:39], s73 offen sc1
    s_mov_b32 s76, 0x7060504
    v_writelane_b32 v116, s76, 2
    s_mov_b32 s76, 0xc0b0a0a
    v_writelane_b32 v116, s76, 3
    s_mov_b32 s76, 0x130f0e0d
    v_writelane_b32 v116, s76, 4
    buffer_load_dwordx4 v[212:215], v216, s[36:39], s73 offen offset:16 sc1
    s_mov_b32 s76, 0x17121110
    v_writelane_b32 v116, s76, 5
    s_mov_b32 s76, 0x161514
    v_writelane_b32 v116, s76, 6
    s_mov_b32 s76, 0x1a1918
    v_writelane_b32 v116, s76, 7
    buffer_load_dwordx4 v[192:195], v248, s[36:39], s77 offen sc1
    v_lshrrev_b32 v117, 2, v109
    v_lshlrev_b32 v117, 2, v117
    ds_bpermute_b32 v116, v117, v116
    v_mul_u32_u24 v111, 528, v109
    v_lshl_add_u32 v111, v110, 4, v111
    v_add_u32 v111, s75, v111
    s_add_u32 s77, s77, 8192
    buffer_load_dwordx4 v[196:199], v248, s[36:39], s77 offen sc1
    s_add_u32 s76, s75, 9088
    v_lshlrev_b32 v112, 4, v109
    v_add_u32 v112, s76, v112
    v_lshl_add_u32 v113, v110, 10, v112
    v_lshl_add_u32 v112, v110, 9, v112
    v_add_f32 v106, v106, v106
    s_add_u32 s77, s77, 8192
    buffer_load_dwordx4 v[200:203], v248, s[36:39], s77 offen sc1
    v_and_b32 v114, 15, v1
    v_lshl_add_u32 v114, v114, 2, s76
    v_mov_b32 v115, 0
    v_and_b32 v117, 3, v1
    v_lshlrev_b32 v117, 3, v117
    s_waitcnt lgkmcnt(0)
    v_bfe_u32 v116, v116, v117, 8
    s_add_u32 s77, s77, 8192
    buffer_load_dwordx4 v[204:207], v248, s[36:39], s77 offen sc1
    v_mul_u32_u24 v116, 528, v116
    v_lshl_add_u32 v116, v110, 4, v116
    s_add_u32 s76, s75, 16896
    v_add_u32 v117, s76, v116
    s_mov_b32 s78, 0xaaaaaaaa
    s_mov_b32 s79, 0xaaaaaaaa
    s_cmp_eq_u32 s2, 0
    s_cselect_b32 s96, 0, 0x7f000000
    v_mov_b32 v94, s34
    v_mov_b32 v95, 0
    buffer_store_dword v94, v95, s[36:39], s96 offen sc1
    ds_read_b128 a[0:3], v117 offset:0
    ds_read_b128 a[4:7], v111 offset:0
    ds_read_b128 a[8:11], v117 offset:32
    ds_read_b128 a[12:15], v111 offset:32
    ds_read_b128 a[16:19], v117 offset:64
    ds_read_b128 a[20:23], v111 offset:64
    s_waitcnt lgkmcnt(4)
    v_mfma_f32_32x32x16_bf16 v[120:135], a[0:3], a[4:7], 0
    ds_read_b128 a[24:27], v117 offset:96
    ds_read_b128 a[28:31], v111 offset:96
    s_waitcnt lgkmcnt(4)
    v_mfma_f32_32x32x16_bf16 v[120:135], a[8:11], a[12:15], v[120:135]
    ds_read_b128 a[32:35], v117 offset:128
    ds_read_b128 a[36:39], v111 offset:128
    s_waitcnt lgkmcnt(4)
    v_mfma_f32_32x32x16_bf16 v[120:135], a[16:19], a[20:23], v[120:135]
    ds_read_b128 a[40:43], v117 offset:160
    ds_read_b128 a[44:47], v111 offset:160
    s_waitcnt lgkmcnt(4)
    v_mfma_f32_32x32x16_bf16 v[120:135], a[24:27], a[28:31], v[120:135]
    ds_read_b128 a[48:51], v117 offset:192
    ds_read_b128 a[52:55], v111 offset:192
    s_waitcnt lgkmcnt(4)
    v_mfma_f32_32x32x16_bf16 v[120:135], a[32:35], a[36:39], v[120:135]
    ds_read_b128 a[56:59], v117 offset:224
    ds_read_b128 a[60:63], v111 offset:224
    s_waitcnt lgkmcnt(4)
    v_mfma_f32_32x32x16_bf16 v[120:135], a[40:43], a[44:47], v[120:135]
    ds_read_b128 a[64:67], v117 offset:256
    ds_read_b128 a[68:71], v111 offset:256
    s_waitcnt lgkmcnt(4)
    v_mfma_f32_32x32x16_bf16 v[120:135], a[48:51], a[52:55], v[120:135]
    ds_read_b128 a[72:75], v117 offset:288
    ds_read_b128 a[76:79], v111 offset:288
    s_waitcnt lgkmcnt(4)
    v_mfma_f32_32x32x16_bf16 v[120:135], a[56:59], a[60:63], v[120:135]
    ds_read_b128 a[80:83], v117 offset:320
    ds_read_b128 a[84:87], v111 offset:320
    s_waitcnt lgkmcnt(4)
    v_mfma_f32_32x32x16_bf16 v[120:135], a[64:67], a[68:71], v[120:135]
    ds_read_b128 a[88:91], v117 offset:352
    ds_read_b128 a[92:95], v111 offset:352
    s_waitcnt lgkmcnt(4)
    v_mfma_f32_32x32x16_bf16 v[120:135], a[72:75], a[76:79], v[120:135]
    ds_read_b128 a[96:99], v117 offset:384
    ds_read_b128 a[100:103], v111 offset:384
    s_waitcnt lgkmcnt(4)
    v_mfma_f32_32x32x16_bf16 v[120:135], a[80:83], a[84:87], v[120:135]
    ds_read_b128 a[104:107], v117 offset:416
    ds_read_b128 a[108:111], v111 offset:416
    s_waitcnt lgkmcnt(4)
    v_mfma_f32_32x32x16_bf16 v[120:135], a[88:91], a[92:95], v[120:135]
    ds_read_b128 a[112:115], v117 offset:448
    ds_read_b128 a[116:119], v111 offset:448
    s_waitcnt lgkmcnt(4)
    v_mfma_f32_32x32x16_bf16 v[120:135], a[96:99], a[100:103], v[120:135]
    ds_read_b128 a[120:123], v117 offset:480
    ds_read_b128 a[124:127], v111 offset:480
    s_waitcnt lgkmcnt(4)
    v_mfma_f32_32x32x16_bf16 v[120:135], a[104:107], a[108:111], v[120:135]
    s_waitcnt lgkmcnt(2)
    v_mfma_f32_32x32x16_bf16 v[120:135], a[112:115], a[116:119], v[120:135]
    s_waitcnt lgkmcnt(0)
    v_mfma_f32_32x32x16_bf16 v[120:135], a[120:123], a[124:127], v[120:135]
    buffer_store_dwordx4 v[236:239], v226, s[36:39], s98 offen sc1
    s_add_u32 s98, s98, 4096
    s_nop 9
    v_pk_mul_f32 v[120:121], v[120:121], v[106:107] op_sel_hi:[1,0]
    v_pk_mul_f32 v[122:123], v[122:123], v[106:107] op_sel_hi:[1,0]
    v_pk_mul_f32 v[124:125], v[124:125], v[106:107] op_sel_hi:[1,0]
    v_pk_mul_f32 v[126:127], v[126:127], v[106:107] op_sel_hi:[1,0]
    v_pk_mul_f32 v[128:129], v[128:129], v[106:107] op_sel_hi:[1,0]
    buffer_store_dwordx4 v[236:239], v226, s[36:39], s98 offen sc1
    s_add_u32 s98, s98, 4096
    v_pk_mul_f32 v[130:131], v[130:131], v[106:107] op_sel_hi:[1,0]
    v_pk_mul_f32 v[132:133], v[132:133], v[106:107] op_sel_hi:[1,0]
    v_pk_mul_f32 v[134:135], v[134:135], v[106:107] op_sel_hi:[1,0]
    v_cvt_pk_bf16_f32 v136, v120, v121
    v_cvt_pk_bf16_f32 v137, v122, v123
    v_cvt_pk_bf16_f32 v138, v124, v125
    buffer_store_dwordx4 v[236:239], v226, s[36:39], s98 offen sc1
    s_add_u32 s98, s98, 4096
    v_cvt_pk_bf16_f32 v139, v126, v127
    v_cvt_pk_bf16_f32 v140, v128, v128
    v_cvt_pk_bf16_f32 v141, v128, v129
    v_cvt_pk_bf16_f32 v142, v129, v129
    v_cvt_pk_bf16_f32 v143, v130, v130
    v_cndmask_b32 v152, v131, v132, s[78:79]
    buffer_store_dwordx4 v[236:239], v226, s[36:39], s98 offen sc1
    s_add_u32 s98, s98, 4096
    v_cvt_pk_bf16_f32 v144, v131, v131
    v_cvt_pk_bf16_f32 v145, v131, v131
    v_cvt_pk_bf16_f32 v146, v152, v132
    v_cvt_pk_bf16_f32 v147, v132, v132
    v_cndmask_b32 v152, v133, v134, s[78:79]
    v_cvt_pk_bf16_f32 v148, v133, v133
    v_cvt_pk_bf16_f32 v149, v133, v133
    v_cvt_pk_bf16_f32 v150, v152, v134
    v_cvt_pk_bf16_f32 v151, v134, v134
    ds_write_b32 v114, v115
    ds_write_b128 v112, v[136:139] offset:64
    ds_write_b128 v112, v[140:143] offset:1088
    ds_write_b128 v113, v[144:147] offset:2112
    ds_write_b128 v113, v[148:151] offset:2624
    s_mov_b32 s78, 0
    s_mov_b32 s79, 0x80800000
    s_mov_b64 exec, 0xfffffff
    ds_write_b128 v217, v[228:231]
    s_mov_b64 exec, -1
    s_waitcnt lgkmcnt(0)
    s_barrier
    s_waitcnt vmcnt(11)
    v_add_f32_dpp v7, v7, v7 row_ror:4 row_mask:0xf bank_mask:0xf
    s_nop 1
    v_add_f32_dpp v7, v7, v7 row_ror:8 row_mask:0xf bank_mask:0xf
    v_cvt_pk_bf16_f32 v7, v7, v7
    v_lshlrev_b32 v7, 16, v7
    v_add_f32 v7, v7, v224
    v_cvt_pk_bf16_f32 v7, v7, v7
    v_lshlrev_b32 v7, 16, v7
    v_mul_f32 v240, v7, v240
    v_readlane_b32 s64, v7, 0
    v_readlane_b32 s65, v7, 1
    v_readlane_b32 s66, v7, 2
    v_readlane_b32 s67, v7, 3
    v_readlane_b32 s80, v7, 16
    v_readlane_b32 s81, v7, 17
    v_readlane_b32 s82, v7, 18
    v_readlane_b32 s83, v7, 19
    v_mov_b32 v232, s64
    v_mov_b32 v233, s65
    v_mov_b32 v234, s66
    v_mov_b32 v235, s67
    v_readlane_b32 s64, v240, 32
    v_readlane_b32 s65, v240, 33
    v_readlane_b32 s66, v240, 34
    v_readlane_b32 s67, v240, 35
    v_readlane_b32 s84, v7, s72
    s_waitcnt vmcnt(10)
    v_and_b32 v160, 0xffff0000, v208
    v_rcp_f32 v160, v160
    v_lshlrev_b32 v161, 16, v208
    v_and_b32 v162, 0xffff0000, v209
    v_rcp_f32 v162, v162
    v_lshlrev_b32 v163, 16, v209
    v_and_b32 v164, 0xffff0000, v210
    v_rcp_f32 v164, v164
    v_lshlrev_b32 v165, 16, v210
    v_and_b32 v166, 0xffff0000, v211
    v_rcp_f32 v166, v166
    v_lshlrev_b32 v167, 16, v211
    s_waitcnt vmcnt(9)
    v_and_b32 v168, 0xffff0000, v212
    v_rcp_f32 v168, v168
    v_lshlrev_b32 v169, 16, v212
    v_and_b32 v170, 0xffff0000, v213
    v_rcp_f32 v170, v170
    v_lshlrev_b32 v171, 16, v213
    v_and_b32 v172, 0xffff0000, v214
    v_rcp_f32 v172, v172
    v_lshlrev_b32 v173, 16, v214
    v_and_b32 v174, 0xffff0000, v215
    v_rcp_f32 v174, v174
    v_lshlrev_b32 v175, 16, v215
    v_mul_f32 v161, -v161, v160
    v_mul_f32 v163, -v163, v162
    v_mul_f32 v165, -v165, v164
    v_mul_f32 v167, -v167, v166
    v_mul_f32 v169, -v169, v168
    v_mul_f32 v171, -v171, v170
    v_mul_f32 v173, -v173, v172
    v_mul_f32 v175, -v175, v174
    s_waitcnt vmcnt(8)
    v_lshlrev_b32 v128, 16, v192
    v_and_b32 v129, 0xffff0000, v192
    v_pk_fma_f32 v[64:65], v[128:129], v[160:161], v[160:161] op_sel:[0,0,1] op_sel_hi:[1,0,1]
    v_pk_fma_f32 v[64:65], v[64:65], s[80:81], v[232:233]
    v_lshlrev_b32 v130, 16, v193
    v_and_b32 v131, 0xffff0000, v193
    v_pk_fma_f32 v[66:67], v[130:131], v[160:161], v[160:161] op_sel:[0,0,1] op_sel_hi:[1,0,1]
    v_pk_fma_f32 v[66:67], v[66:67], s[82:83], v[234:235]
    v_lshlrev_b32 v132, 16, v194
    v_and_b32 v133, 0xffff0000, v194
    v_pk_fma_f32 v[68:69], v[132:133], v[162:163], v[162:163] op_sel:[0,0,1] op_sel_hi:[1,0,1]
    v_pk_fma_f32 v[68:69], v[68:69], s[80:81], v[232:233]
    v_lshlrev_b32 v134, 16, v195
    v_and_b32 v135, 0xffff0000, v195
    v_pk_fma_f32 v[70:71], v[134:135], v[162:163], v[162:163] op_sel:[0,0,1] op_sel_hi:[1,0,1]
    v_pk_fma_f32 v[70:71], v[70:71], s[82:83], v[234:235]
    s_waitcnt vmcnt(7)
    v_lshlrev_b32 v136, 16, v196
    v_and_b32 v137, 0xffff0000, v196
    v_pk_fma_f32 v[72:73], v[136:137], v[164:165], v[164:165] op_sel:[0,0,1] op_sel_hi:[1,0,1]
    v_pk_fma_f32 v[72:73], v[72:73], s[80:81], v[232:233]
    v_lshlrev_b32 v138, 16, v197
    v_and_b32 v139, 0xffff0000, v197
    v_pk_fma_f32 v[74:75], v[138:139], v[164:165], v[164:165] op_sel:[0,0,1] op_sel_hi:[1,0,1]
    v_pk_fma_f32 v[74:75], v[74:75], s[82:83], v[234:235]
    v_lshlrev_b32 v140, 16, v198
    v_and_b32 v141, 0xffff0000, v198
    v_pk_fma_f32 v[76:77], v[140:141], v[166:167], v[166:167] op_sel:[0,0,1] op_sel_hi:[1,0,1]
    v_pk_fma_f32 v[76:77], v[76:77], s[80:81], v[232:233]
    v_lshlrev_b32 v142, 16, v199
    v_and_b32 v143, 0xffff0000, v199
    v_pk_fma_f32 v[78:79], v[142:143], v[166:167], v[166:167] op_sel:[0,0,1] op_sel_hi:[1,0,1]
    v_pk_fma_f32 v[78:79], v[78:79], s[82:83], v[234:235]
    s_waitcnt vmcnt(6)
    v_lshlrev_b32 v144, 16, v200
    v_and_b32 v145, 0xffff0000, v200
    v_pk_fma_f32 v[80:81], v[144:145], v[168:169], v[168:169] op_sel:[0,0,1] op_sel_hi:[1,0,1]
    v_pk_fma_f32 v[80:81], v[80:81], s[80:81], v[232:233]
    v_lshlrev_b32 v146, 16, v201
    v_and_b32 v147, 0xffff0000, v201
    v_pk_fma_f32 v[82:83], v[146:147], v[168:169], v[168:169] op_sel:[0,0,1] op_sel_hi:[1,0,1]
    v_pk_fma_f32 v[82:83], v[82:83], s[82:83], v[234:235]
    v_lshlrev_b32 v148, 16, v202
    v_and_b32 v149, 0xffff0000, v202
    v_pk_fma_f32 v[84:85], v[148:149], v[170:171], v[170:171] op_sel:[0,0,1] op_sel_hi:[1,0,1]
    v_pk_fma_f32 v[84:85], v[84:85], s[80:81], v[232:233]
    v_lshlrev_b32 v150, 16, v203
    v_and_b32 v151, 0xffff0000, v203
    v_pk_fma_f32 v[86:87], v[150:151], v[170:171], v[170:171] op_sel:[0,0,1] op_sel_hi:[1,0,1]
    v_pk_fma_f32 v[86:87], v[86:87], s[82:83], v[234:235]
    s_waitcnt vmcnt(5)
    v_lshlrev_b32 v152, 16, v204
    v_and_b32 v153, 0xffff0000, v204
    v_pk_fma_f32 v[88:89], v[152:153], v[172:173], v[172:173] op_sel:[0,0,1] op_sel_hi:[1,0,1]
    v_pk_fma_f32 v[88:89], v[88:89], s[80:81], v[232:233]
    v_lshlrev_b32 v154, 16, v205
    v_and_b32 v155, 0xffff0000, v205
    v_pk_fma_f32 v[90:91], v[154:155], v[172:173], v[172:173] op_sel:[0,0,1] op_sel_hi:[1,0,1]
    v_pk_fma_f32 v[90:91], v[90:91], s[82:83], v[234:235]
    v_lshlrev_b32 v156, 16, v206
    v_and_b32 v157, 0xffff0000, v206
    v_pk_fma_f32 v[92:93], v[156:157], v[174:175], v[174:175] op_sel:[0,0,1] op_sel_hi:[1,0,1]
    v_pk_fma_f32 v[92:93], v[92:93], s[80:81], v[232:233]
    v_lshlrev_b32 v158, 16, v207
    v_and_b32 v159, 0xffff0000, v207
    v_pk_fma_f32 v[94:95], v[158:159], v[174:175], v[174:175] op_sel:[0,0,1] op_sel_hi:[1,0,1]
    v_pk_fma_f32 v[94:95], v[94:95], s[82:83], v[234:235]
    v_cvt_pk_bf16_f32 v96, v64, v68
    v_cvt_pk_bf16_f32 v97, v72, v76
    v_cvt_pk_bf16_f32 v98, v80, v84
    v_cvt_pk_bf16_f32 v99, v88, v92
    ds_write_b128 v241, v[96:99] offset:112
    v_cvt_pk_bf16_f32 v100, v65, v69
    v_cvt_pk_bf16_f32 v101, v73, v77
    v_cvt_pk_bf16_f32 v102, v81, v85
    v_cvt_pk_bf16_f32 v103, v89, v93
    ds_write_b128 v241, v[100:103] offset:33904
    v_cvt_pk_bf16_f32 v104, v66, v70
    v_cvt_pk_bf16_f32 v105, v74, v78
    v_cvt_pk_bf16_f32 v106, v82, v86
    v_cvt_pk_bf16_f32 v107, v90, v94
    ds_write_b128 v242, v[104:107] offset:112
    v_cvt_pk_bf16_f32 v108, v67, v71
    v_cvt_pk_bf16_f32 v109, v75, v79
    v_cvt_pk_bf16_f32 v110, v83, v87
    v_cvt_pk_bf16_f32 v111, v91, v95
    ds_write_b128 v242, v[108:111] offset:33904
    v_pk_fma_f32 v[64:65], v[64:65], s[64:65], v[128:129]
    v_pk_fma_f32 v[66:67], v[66:67], s[66:67], v[130:131]
    v_pk_fma_f32 v[68:69], v[68:69], s[64:65], v[132:133]
    v_pk_fma_f32 v[70:71], v[70:71], s[66:67], v[134:135]
    v_pk_fma_f32 v[72:73], v[72:73], s[64:65], v[136:137]
    v_pk_fma_f32 v[74:75], v[74:75], s[66:67], v[138:139]
    v_pk_fma_f32 v[76:77], v[76:77], s[64:65], v[140:141]
    v_pk_fma_f32 v[78:79], v[78:79], s[66:67], v[142:143]
    v_pk_fma_f32 v[80:81], v[80:81], s[64:65], v[144:145]
    v_pk_fma_f32 v[82:83], v[82:83], s[66:67], v[146:147]
    v_pk_fma_f32 v[84:85], v[84:85], s[64:65], v[148:149]
    v_pk_fma_f32 v[86:87], v[86:87], s[66:67], v[150:151]
    v_pk_fma_f32 v[88:89], v[88:89], s[64:65], v[152:153]
    v_pk_fma_f32 v[90:91], v[90:91], s[66:67], v[154:155]
    v_pk_fma_f32 v[92:93], v[92:93], s[64:65], v[156:157]
    v_pk_fma_f32 v[94:95], v[94:95], s[66:67], v[158:159]
    v_cvt_pk_bf16_f32 v112, v64, v68
    v_cvt_pk_bf16_f32 v113, v72, v76
    v_cvt_pk_bf16_f32 v114, v80, v84
    v_cvt_pk_bf16_f32 v115, v88, v92
    ds_write_b128 v241, v[112:115] offset:4608
    v_cvt_pk_bf16_f32 v116, v65, v69
    v_cvt_pk_bf16_f32 v117, v73, v77
    v_cvt_pk_bf16_f32 v118, v81, v85
    v_cvt_pk_bf16_f32 v119, v89, v93
    ds_write_b128 v241, v[116:119] offset:38400
    v_cvt_pk_bf16_f32 v120, v66, v70
    v_cvt_pk_bf16_f32 v121, v74, v78
    v_cvt_pk_bf16_f32 v122, v82, v86
    v_cvt_pk_bf16_f32 v123, v90, v94
    ds_write_b128 v242, v[120:123] offset:4608
    v_cvt_pk_bf16_f32 v124, v67, v71
    v_cvt_pk_bf16_f32 v125, v75, v79
    v_cvt_pk_bf16_f32 v126, v83, v87
    v_cvt_pk_bf16_f32 v127, v91, v95
    ds_write_b128 v242, v[124:127] offset:38400
    s_waitcnt vmcnt(0)
    s_waitcnt lgkmcnt(0)
    s_barrier
    s_lshl_b32 s96, s71, 2
    s_add_u32 s96, s96, 0xd000
    s_cmp_eq_u32 s60, 0
    s_cselect_b32 s96, s96, 0x7f000000
    v_mov_b32 v94, s34
    v_mul_u32_u24 v95, 1536, v1
    s_mov_b32 exec_hi, 0
    s_mov_b32 exec_lo, 0xffffffff
    buffer_store_dword v94, v95, s[36:39], s96 offen sc1
    s_mov_b64 exec, -1
    ds_read_b128 a[12:15], v219 offset:96
    ds_read_b64_tr_b16 a[128:129], v218 offset:32
    ds_read_b64_tr_b16 a[130:131], v218 offset:0
    ds_read_b128 a[8:11], v219 offset:64
    ds_read_b64_tr_b16 a[132:133], v218 offset:160
    ds_read_b64_tr_b16 a[134:135], v218 offset:128
    ds_read_b128 a[4:7], v219 offset:32
    ds_read_b64_tr_b16 a[136:137], v218 offset:288
    ds_read_b64_tr_b16 a[138:139], v218 offset:256
    ds_read_b128 a[0:3], v219 offset:0
    ds_read_b64_tr_b16 a[140:141], v218 offset:416
    ds_read_b64_tr_b16 a[142:143], v218 offset:384
    ds_read_b128 a[28:31], v219 offset:224
    ds_read_b128 a[24:27], v219 offset:192
    s_waitcnt lgkmcnt(11)
    v_mfma_f32_32x32x16_bf16 v[128:143], a[128:131], a[12:15], 0
    ds_read_b128 a[20:23], v219 offset:160
    s_waitcnt lgkmcnt(9)
    ds_read_b128 a[16:19], v219 offset:128
    ds_read_b64_tr_b16 a[144:145], v218 offset:544
    v_mfma_f32_32x32x16_bf16 v[128:143], a[132:135], a[8:11], v[128:143]
    ds_read_b64_tr_b16 a[146:147], v218 offset:512
    s_waitcnt lgkmcnt(9)
    ds_read_b64_tr_b16 a[148:149], v218 offset:672
    ds_read_b64_tr_b16 a[150:151], v218 offset:640
    v_mfma_f32_32x32x16_bf16 v[128:143], a[136:139], a[4:7], v[128:143]
    ds_read_b64_tr_b16 a[152:153], v218 offset:800
    s_waitcnt lgkmcnt(7)
    ds_read_b64_tr_b16 a[154:155], v218 offset:768
    v_mfma_f32_32x32x16_bf16 v[128:143], a[140:143], a[0:3], v[128:143]
    ds_read_b64_tr_b16 a[156:157], v218 offset:928
    ds_read_b64_tr_b16 a[158:159], v218 offset:896
    v_mfma_f32_32x32x16_bf16 v[144:159], a[128:131], a[28:31], 0
    ds_read_b128 a[44:47], v219 offset:352
    v_mfma_f32_32x32x16_bf16 v[144:159], a[132:135], a[24:27], v[144:159]
    ds_read_b128 a[40:43], v219 offset:320
    s_waitcnt lgkmcnt(6)
    v_mfma_f32_32x32x16_bf16 v[144:159], a[136:139], a[20:23], v[144:159]
    ds_read_b128 a[36:39], v219 offset:288
    v_mfma_f32_32x32x16_bf16 v[144:159], a[140:143], a[16:19], v[144:159]
    ds_read_b128 a[32:35], v219 offset:256
    v_mfma_f32_32x32x16_bf16 v[144:159], a[144:147], a[12:15], v[144:159]
    v_permlane16_swap_b32 v135, v143
    v_permlane16_swap_b32 v134, v142
    v_cndmask_b32 v24, v143, v225, s[78:79]
    v_mfma_f32_32x32x16_bf16 v[144:159], a[148:151], a[8:11], v[144:159]
    s_waitcnt lgkmcnt(2)
    v_permlane16_swap_b32 v133, v141
    ds_bpermute_b32 v24, v222, v24
    v_mfma_f32_32x32x16_bf16 v[144:159], a[152:155], a[4:7], v[144:159]
    v_add_f32 v135, v135, v142
    v_add_f32 v134, v134, v141
    v_cndmask_b32 v26, v135, v225, s[78:79]
    v_cndmask_b32 v25, v134, v225, s[78:79]
    v_mfma_f32_32x32x16_bf16 v[144:159], a[156:159], a[0:3], v[144:159]
    ds_bpermute_b32 v26, v223, v26
    ds_bpermute_b32 v25, v223, v25
    v_mfma_f32_32x32x16_bf16 v[160:175], a[128:131], a[44:47], 0
    ds_read_b64_tr_b16 a[160:161], v218 offset:1056
    ds_read_b64_tr_b16 a[162:163], v218 offset:1024
    v_permlane16_swap_b32 v132, v140
    v_mfma_f32_32x32x16_bf16 v[160:175], a[132:135], a[40:43], v[160:175]
    ds_read_b64_tr_b16 a[164:165], v218 offset:1184
    s_waitcnt lgkmcnt(5)
    ds_read_b64_tr_b16 a[166:167], v218 offset:1152
    ds_read_u16_d16_hi v20, v220 offset:4496
    v_mfma_f32_32x32x16_bf16 v[160:175], a[136:139], a[36:39], v[160:175]
    ds_read_b64_tr_b16 a[168:169], v218 offset:1312
    ds_read_b64_tr_b16 a[170:171], v218 offset:1280
    v_permlane16_swap_b32 v131, v139
    v_mfma_f32_32x32x16_bf16 v[160:175], a[140:143], a[32:35], v[160:175]
    ds_read_b64_tr_b16 a[172:173], v218 offset:1440
    ds_read_b64_tr_b16 a[174:175], v218 offset:1408
    ds_read_u16_d16_hi v21, v220 offset:5648
    v_mfma_f32_32x32x16_bf16 v[160:175], a[144:147], a[28:31], v[160:175]
    ds_read_b128 a[60:63], v219 offset:480
    v_permlane16_swap_b32 v130, v138
    ds_read_u16_d16_hi v22, v220 offset:6800
    v_mfma_f32_32x32x16_bf16 v[160:175], a[148:151], a[24:27], v[160:175]
    ds_read_b128 a[56:59], v219 offset:448
    v_permlane16_swap_b32 v129, v137
    ds_read_u16_d16_hi v23, v220 offset:7952
    v_mfma_f32_32x32x16_bf16 v[160:175], a[152:155], a[20:23], v[160:175]
    ds_read_b128 a[52:55], v219 offset:416
    v_permlane16_swap_b32 v128, v136
    v_add_f32 v133, v133, v140
    v_add_f32 v132, v132, v139
    v_add_f32 v131, v131, v138
    v_mfma_f32_32x32x16_bf16 v[160:175], a[156:159], a[16:19], v[160:175]
    ds_read_b128 a[48:51], v219 offset:384
    s_waitcnt lgkmcnt(4)
    v_add_f32 v130, v130, v137
    v_add_f32 v129, v129, v136
    v_add_f32 v128, v128, v24
    v_add_f32 v29, v129, v26
    v_add_f32_dpp v31, v129, v131 row_ror:8 row_mask:0xf bank_mask:0xf
    v_mfma_f32_32x32x16_bf16 v[160:175], a[160:163], a[12:15], v[160:175]
    v_add_f32 v28, v128, v25
    v_add_f32_dpp v30, v128, v130 row_ror:8 row_mask:0xf bank_mask:0xf
    v_add_f32_dpp v29, v133, v131 row_ror:8 row_mask:0xf bank_mask:0xc
    v_add_f32_dpp v31, v135, v133 row_ror:8 row_mask:0xf bank_mask:0xc
    v_add_f32_dpp v28, v132, v130 row_ror:8 row_mask:0xf bank_mask:0xc
    v_add_f32_dpp v30, v134, v132 row_ror:8 row_mask:0xf bank_mask:0xc
    v_mfma_f32_32x32x16_bf16 v[160:175], a[164:167], a[8:11], v[160:175]
    v_fmac_f32 v21, s84, v29
    s_waitcnt lgkmcnt(1)
    v_fmac_f32 v23, s84, v31
    v_fmac_f32 v20, s84, v28
    v_fmac_f32 v22, s84, v30
    v_cvt_pk_bf16_f32 v32, v20, v21
    v_mfma_f32_32x32x16_bf16 v[160:175], a[168:171], a[4:7], v[160:175]
    v_cvt_pk_bf16_f32 v33, v22, v23
    ds_write_b64 v221, v[32:33] offset:0
    v_mfma_f32_32x32x16_bf16 v[160:175], a[172:175], a[0:3], v[160:175]
    v_permlane16_swap_b32 v151, v159
    v_permlane16_swap_b32 v150, v158
    v_cndmask_b32 v48, v159, v143, s[78:79]
    v_mfma_f32_32x32x16_bf16 v[176:191], a[128:131], a[60:63], 0
    v_permlane16_swap_b32 v149, v157
    ds_bpermute_b32 v48, v222, v48
    v_mfma_f32_32x32x16_bf16 v[176:191], a[132:135], a[56:59], v[176:191]
    v_add_f32 v151, v151, v158
    v_add_f32 v150, v150, v157
    v_cndmask_b32 v50, v151, v135, s[78:79]
    v_cndmask_b32 v49, v150, v134, s[78:79]
    v_mfma_f32_32x32x16_bf16 v[176:191], a[136:139], a[52:55], v[176:191]
    ds_bpermute_b32 v50, v223, v50
    s_waitcnt lgkmcnt(2)
    ds_bpermute_b32 v49, v223, v49
    v_mfma_f32_32x32x16_bf16 v[176:191], a[140:143], a[48:51], v[176:191]
    v_permlane16_swap_b32 v148, v156
    ds_read_u16_d16_hi v44, v220 offset:4624
    v_mfma_f32_32x32x16_bf16 v[176:191], a[144:147], a[44:47], v[176:191]
    ds_read_b64_tr_b16 a[176:177], v218 offset:1568
    ds_read_b64_tr_b16 a[178:179], v218 offset:1536
    v_permlane16_swap_b32 v147, v155
    v_mfma_f32_32x32x16_bf16 v[176:191], a[148:151], a[40:43], v[176:191]
    ds_read_b64_tr_b16 a[180:181], v218 offset:1696
    ds_read_b64_tr_b16 a[182:183], v218 offset:1664
    ds_read_u16_d16_hi v45, v220 offset:5776
    v_mfma_f32_32x32x16_bf16 v[176:191], a[152:155], a[36:39], v[176:191]
    ds_read_b64_tr_b16 a[184:185], v218 offset:1824
    ds_read_b64_tr_b16 a[186:187], v218 offset:1792
    v_permlane16_swap_b32 v146, v154
    v_mfma_f32_32x32x16_bf16 v[176:191], a[156:159], a[32:35], v[176:191]
    ds_read_b64_tr_b16 a[188:189], v218 offset:1952
    ds_read_b64_tr_b16 a[190:191], v218 offset:1920
    ds_read_u16_d16_hi v46, v220 offset:6928
    v_mfma_f32_32x32x16_bf16 v[176:191], a[160:163], a[28:31], v[176:191]
    ds_read_b128 a[76:79], v219 offset:608
    v_permlane16_swap_b32 v145, v153
    ds_read_u16_d16_hi v47, v220 offset:8080
    v_mfma_f32_32x32x16_bf16 v[176:191], a[164:167], a[24:27], v[176:191]
    ds_read_b128 a[72:75], v219 offset:576
    v_permlane16_swap_b32 v144, v152
    v_add_f32 v149, v149, v156
    v_add_f32 v148, v148, v155
    v_add_f32 v147, v147, v154
    v_mfma_f32_32x32x16_bf16 v[176:191], a[168:171], a[20:23], v[176:191]
    ds_read_b128 a[68:71], v219 offset:544
    v_add_f32 v146, v146, v153
    v_add_f32 v145, v145, v152
    s_waitcnt lgkmcnt(4)
    v_add_f32 v144, v144, v48
    v_add_f32 v53, v145, v50
    v_mfma_f32_32x32x16_bf16 v[176:191], a[172:175], a[16:19], v[176:191]
    ds_read_b128 a[64:67], v219 offset:512
    v_add_f32_dpp v55, v145, v147 row_ror:8 row_mask:0xf bank_mask:0xf
    v_add_f32 v52, v144, v49
    v_add_f32_dpp v54, v144, v146 row_ror:8 row_mask:0xf bank_mask:0xf
    v_add_f32_dpp v53, v149, v147 row_ror:8 row_mask:0xf bank_mask:0xc
    v_add_f32_dpp v55, v151, v149 row_ror:8 row_mask:0xf bank_mask:0xc
    v_mfma_f32_32x32x16_bf16 v[176:191], a[176:179], a[12:15], v[176:191]
    v_add_f32_dpp v52, v148, v146 row_ror:8 row_mask:0xf bank_mask:0xc
    v_add_f32_dpp v54, v150, v148 row_ror:8 row_mask:0xf bank_mask:0xc
    v_fmac_f32 v45, s84, v53
    s_waitcnt lgkmcnt(2)
    v_fmac_f32 v47, s84, v55
    v_fmac_f32 v44, s84, v52
    v_mfma_f32_32x32x16_bf16 v[176:191], a[180:183], a[8:11], v[176:191]
    v_fmac_f32 v46, s84, v54
    v_cvt_pk_bf16_f32 v56, v44, v45
    v_cvt_pk_bf16_f32 v57, v46, v47
    v_mfma_f32_32x32x16_bf16 v[176:191], a[184:187], a[4:7], v[176:191]
    ds_write_b64 v221, v[56:57] offset:512
    v_permlane16_swap_b32 v167, v175
    v_mfma_f32_32x32x16_bf16 v[176:191], a[188:191], a[0:3], v[176:191]
    v_permlane16_swap_b32 v166, v174
    v_cndmask_b32 v24, v175, v159, s[78:79]
    v_permlane16_swap_b32 v165, v173
    v_mfma_f32_32x32x16_bf16 v[128:143], a[128:131], a[76:79], 0
    ds_bpermute_b32 v24, v222, v24
    v_add_f32 v167, v167, v174
    v_add_f32 v166, v166, v173
    v_cndmask_b32 v26, v167, v151, s[78:79]
    v_cndmask_b32 v25, v166, v150, s[78:79]
    v_mfma_f32_32x32x16_bf16 v[128:143], a[132:135], a[72:75], v[128:143]
    ds_bpermute_b32 v26, v223, v26
    s_waitcnt lgkmcnt(2)
    ds_bpermute_b32 v25, v223, v25
    v_mfma_f32_32x32x16_bf16 v[128:143], a[136:139], a[68:71], v[128:143]
    buffer_atomic_or_x2 v[60:61], v247, s[36:39], s74 offen sc0 sc1
    v_permlane16_swap_b32 v164, v172
    v_mfma_f32_32x32x16_bf16 v[128:143], a[140:143], a[64:67], v[128:143]
    ds_read_u16_d16_hi v20, v220 offset:4752
    v_permlane16_swap_b32 v163, v171
    ds_read_u16_d16_hi v21, v220 offset:5904
    v_mfma_f32_32x32x16_bf16 v[128:143], a[144:147], a[60:63], v[128:143]
    v_permlane16_swap_b32 v162, v170
    ds_read_u16_d16_hi v22, v220 offset:7056
    v_mfma_f32_32x32x16_bf16 v[128:143], a[148:151], a[56:59], v[128:143]
    v_permlane16_swap_b32 v161, v169
    ds_read_u16_d16_hi v23, v220 offset:8208
    v_mfma_f32_32x32x16_bf16 v[128:143], a[152:155], a[52:55], v[128:143]
    v_permlane16_swap_b32 v160, v168
    v_add_f32 v165, v165, v172
    v_add_f32 v164, v164, v171
    v_add_f32 v163, v163, v170
    v_add_f32 v162, v162, v169
    v_mfma_f32_32x32x16_bf16 v[128:143], a[156:159], a[48:51], v[128:143]
    v_add_f32 v161, v161, v168
    s_waitcnt lgkmcnt(1)
    v_add_f32 v160, v160, v24
    v_add_f32 v29, v161, v26
    v_add_f32_dpp v31, v161, v163 row_ror:8 row_mask:0xf bank_mask:0xf
    v_add_f32 v28, v160, v25
    v_mfma_f32_32x32x16_bf16 v[128:143], a[160:163], a[44:47], v[128:143]
    ds_read_b64_tr_b16 a[192:193], v218 offset:2080
    ds_read_b64_tr_b16 a[194:195], v218 offset:2048
    v_add_f32_dpp v30, v160, v162 row_ror:8 row_mask:0xf bank_mask:0xf
    v_add_f32_dpp v29, v165, v163 row_ror:8 row_mask:0xf bank_mask:0xc
    v_add_f32_dpp v31, v167, v165 row_ror:8 row_mask:0xf bank_mask:0xc
    v_mfma_f32_32x32x16_bf16 v[128:143], a[164:167], a[40:43], v[128:143]
    ds_read_b64_tr_b16 a[196:197], v218 offset:2208
    ds_read_b64_tr_b16 a[198:199], v218 offset:2176
    v_add_f32_dpp v28, v164, v162 row_ror:8 row_mask:0xf bank_mask:0xc
    v_add_f32_dpp v30, v166, v164 row_ror:8 row_mask:0xf bank_mask:0xc
    v_fmac_f32 v21, s84, v29
    v_mfma_f32_32x32x16_bf16 v[128:143], a[168:171], a[36:39], v[128:143]
    ds_read_b64_tr_b16 a[200:201], v218 offset:2336
    ds_read_b64_tr_b16 a[202:203], v218 offset:2304
    s_waitcnt lgkmcnt(6)
    v_fmac_f32 v23, s84, v31
    v_fmac_f32 v20, s84, v28
    v_fmac_f32 v22, s84, v30
    v_mfma_f32_32x32x16_bf16 v[128:143], a[172:175], a[32:35], v[128:143]
    ds_read_b64_tr_b16 a[204:205], v218 offset:2464
    ds_read_b64_tr_b16 a[206:207], v218 offset:2432
    v_cvt_pk_bf16_f32 v32, v20, v21
    v_cvt_pk_bf16_f32 v33, v22, v23
    v_mfma_f32_32x32x16_bf16 v[128:143], a[176:179], a[28:31], v[128:143]
    ds_read_b128 a[92:95], v219 offset:736
    ds_write_b64 v221, v[32:33] offset:1024
    v_mfma_f32_32x32x16_bf16 v[128:143], a[180:183], a[24:27], v[128:143]
    ds_read_b128 a[88:91], v219 offset:704
    v_permlane16_swap_b32 v183, v191
    v_permlane16_swap_b32 v182, v190
    v_cndmask_b32 v48, v191, v175, s[78:79]
    v_mfma_f32_32x32x16_bf16 v[128:143], a[184:187], a[20:23], v[128:143]
    ds_read_b128 a[84:87], v219 offset:672
    v_permlane16_swap_b32 v181, v189
    v_mfma_f32_32x32x16_bf16 v[128:143], a[188:191], a[16:19], v[128:143]
    ds_read_b128 a[80:83], v219 offset:640
    s_waitcnt lgkmcnt(4)
    ds_bpermute_b32 v48, v222, v48
    v_add_f32 v183, v183, v190
    v_add_f32 v182, v182, v189
    v_mfma_f32_32x32x16_bf16 v[128:143], a[192:195], a[12:15], v[128:143]
    v_cndmask_b32 v50, v183, v167, s[78:79]
    v_cndmask_b32 v49, v182, v166, s[78:79]
    ds_bpermute_b32 v50, v223, v50
    v_mfma_f32_32x32x16_bf16 v[128:143], a[196:199], a[8:11], v[128:143]
    ds_bpermute_b32 v49, v223, v49
    v_permlane16_swap_b32 v180, v188
    v_mfma_f32_32x32x16_bf16 v[128:143], a[200:203], a[4:7], v[128:143]
    ds_read_u16_d16_hi v44, v220 offset:4880
    v_permlane16_swap_b32 v179, v187
    ds_read_u16_d16_hi v45, v220 offset:6032
    v_mfma_f32_32x32x16_bf16 v[128:143], a[204:207], a[0:3], v[128:143]
    v_permlane16_swap_b32 v178, v186
    ds_read_u16_d16_hi v46, v220 offset:7184
    v_mfma_f32_32x32x16_bf16 v[144:159], a[128:131], a[92:95], 0
    s_waitcnt lgkmcnt(4)
    v_permlane16_swap_b32 v177, v185
    ds_read_u16_d16_hi v47, v220 offset:8336
    v_mfma_f32_32x32x16_bf16 v[144:159], a[132:135], a[88:91], v[144:159]
    v_permlane16_swap_b32 v176, v184
    v_add_f32 v181, v181, v188
    v_add_f32 v180, v180, v187
    v_add_f32 v179, v179, v186
    v_add_f32 v178, v178, v185
    v_mfma_f32_32x32x16_bf16 v[144:159], a[136:139], a[84:87], v[144:159]
    v_add_f32 v177, v177, v184
    v_add_f32 v176, v176, v48
    v_add_f32 v53, v177, v50
    v_add_f32_dpp v55, v177, v179 row_ror:8 row_mask:0xf bank_mask:0xf
    s_waitcnt lgkmcnt(1)
    v_add_f32 v52, v176, v49
    v_mfma_f32_32x32x16_bf16 v[144:159], a[140:143], a[80:83], v[144:159]
    v_add_f32_dpp v54, v176, v178 row_ror:8 row_mask:0xf bank_mask:0xf
    v_add_f32_dpp v53, v181, v179 row_ror:8 row_mask:0xf bank_mask:0xc
    v_add_f32_dpp v55, v183, v181 row_ror:8 row_mask:0xf bank_mask:0xc
    v_add_f32_dpp v52, v180, v178 row_ror:8 row_mask:0xf bank_mask:0xc
    v_add_f32_dpp v54, v182, v180 row_ror:8 row_mask:0xf bank_mask:0xc
    v_fmac_f32 v45, s84, v53
    v_mfma_f32_32x32x16_bf16 v[144:159], a[144:147], a[76:79], v[144:159]
    s_waitcnt lgkmcnt(0)
    v_fmac_f32 v47, s84, v55
    v_fmac_f32 v44, s84, v52
    v_fmac_f32 v46, s84, v54
    v_cvt_pk_bf16_f32 v56, v44, v45
    v_cvt_pk_bf16_f32 v57, v46, v47
    v_mfma_f32_32x32x16_bf16 v[144:159], a[148:151], a[72:75], v[144:159]
    ds_write_b64 v221, v[56:57] offset:1536
    v_permlane16_swap_b32 v135, v143
    v_mfma_f32_32x32x16_bf16 v[144:159], a[152:155], a[68:71], v[144:159]
    v_permlane16_swap_b32 v134, v142
    v_cndmask_b32 v24, v143, v191, s[78:79]
    v_permlane16_swap_b32 v133, v141
    v_mfma_f32_32x32x16_bf16 v[144:159], a[156:159], a[64:67], v[144:159]
    ds_bpermute_b32 v24, v222, v24
    v_add_f32 v135, v135, v142
    v_add_f32 v134, v134, v141
    v_cndmask_b32 v26, v135, v183, s[78:79]
    v_cndmask_b32 v25, v134, v182, s[78:79]
    v_mfma_f32_32x32x16_bf16 v[144:159], a[160:163], a[60:63], v[144:159]
    ds_bpermute_b32 v26, v223, v26
    ds_bpermute_b32 v25, v223, v25
    v_mfma_f32_32x32x16_bf16 v[144:159], a[164:167], a[56:59], v[144:159]
    v_permlane16_swap_b32 v132, v140
    ds_read_u16_d16_hi v20, v220 offset:5008
    v_mfma_f32_32x32x16_bf16 v[144:159], a[168:171], a[52:55], v[144:159]
    v_permlane16_swap_b32 v131, v139
    ds_read_u16_d16_hi v21, v220 offset:6160
    v_mfma_f32_32x32x16_bf16 v[144:159], a[172:175], a[48:51], v[144:159]
    v_permlane16_swap_b32 v130, v138
    ds_read_u16_d16_hi v22, v220 offset:7312
    v_mfma_f32_32x32x16_bf16 v[144:159], a[176:179], a[44:47], v[144:159]
    ds_read_b64_tr_b16 a[208:209], v218 offset:2592
    ds_read_b64_tr_b16 a[210:211], v218 offset:2560
    s_waitcnt vmcnt(0)
    v_xor_b32 v60, s34, v60
    v_xor_b32 v61, s34, v61
    v_or_b32 v60, v60, v61
    v_mfma_f32_32x32x16_bf16 v[144:159], a[180:183], a[40:43], v[144:159]
    ds_read_b64_tr_b16 a[212:213], v218 offset:2720
    ds_read_b64_tr_b16 a[214:215], v218 offset:2688
    v_cmp_ne_u32 s[56:57], 0, v60
    v_permlane16_swap_b32 v129, v137
    v_mfma_f32_32x32x16_bf16 v[144:159], a[184:187], a[36:39], v[144:159]
    ds_read_b64_tr_b16 a[216:217], v218 offset:2848
    s_and_b32 s57, s57, 0xff
    s_cmp_lg_u64 s[56:57], 0
    s_cbranch_scc0 F_h3
    s_mov_b32 s97, 0
F_h3_l:
    s_sleep 1
    buffer_load_dword v60, v225, s[36:39], s89 offen offset:0 sc1
    s_add_u32 s97, s97, 1
    s_waitcnt vmcnt(0)
    v_cmp_ne_u32 s[56:57], s34, v60
    s_nop 1
    s_cmp_lg_u64 s[56:57], 0
    s_cbranch_scc0 F_h3
    s_cmp_lt_u32 s97, 0x40000
    s_cbranch_scc1 F_h3_l
F_h3:
    v_mfma_f32_32x32x16_bf16 v[144:159], a[188:191], a[32:35], v[144:159]
    ds_read_b64_tr_b16 a[218:219], v218 offset:2816
    ds_read_b64_tr_b16 a[220:221], v218 offset:2976
    ds_read_b64_tr_b16 a[222:223], v218 offset:2944
    v_mfma_f32_32x32x16_bf16 v[144:159], a[192:195], a[28:31], v[144:159]
    ds_read_b128 a[108:111], v219 offset:864
    buffer_load_dwordx4 v243, s[36:39], s63 offen offset:0 sc1 lds
    buffer_load_dwordx4 v243, s[36:39], s63 offen offset:1024 sc1 lds
    v_mfma_f32_32x32x16_bf16 v[144:159], a[196:199], a[24:27], v[144:159]
    ds_read_b128 a[104:107], v219 offset:832
    ds_read_u16_d16_hi v23, v220 offset:8464
    v_permlane16_swap_b32 v128, v136
    v_add_f32 v133, v133, v140
    v_mfma_f32_32x32x16_bf16 v[144:159], a[200:203], a[20:23], v[144:159]
    ds_read_b128 a[100:103], v219 offset:800
    v_add_f32 v132, v132, v139
    v_add_f32 v131, v131, v138
    v_add_f32 v130, v130, v137
    v_add_f32 v129, v129, v136
    v_mfma_f32_32x32x16_bf16 v[144:159], a[204:207], a[16:19], v[144:159]
    ds_read_b128 a[96:99], v219 offset:768
    s_waitcnt lgkmcnt(4)
    buffer_load_dwordx4 v243, s[36:39], s63 offen offset:2048 sc1 lds
    v_add_f32 v128, v128, v24
    v_add_f32 v29, v129, v26
    v_add_f32_dpp v31, v129, v131 row_ror:8 row_mask:0xf bank_mask:0xf
    v_mfma_f32_32x32x16_bf16 v[144:159], a[208:211], a[12:15], v[144:159]
    v_add_f32 v28, v128, v25
    v_add_f32_dpp v30, v128, v130 row_ror:8 row_mask:0xf bank_mask:0xf
    v_add_f32_dpp v29, v133, v131 row_ror:8 row_mask:0xf bank_mask:0xc
    v_add_f32_dpp v31, v135, v133 row_ror:8 row_mask:0xf bank_mask:0xc
    v_add_f32_dpp v28, v132, v130 row_ror:8 row_mask:0xf bank_mask:0xc
    v_add_f32_dpp v30, v134, v132 row_ror:8 row_mask:0xf bank_mask:0xc
    v_mfma_f32_32x32x16_bf16 v[144:159], a[212:215], a[8:11], v[144:159]
    v_fmac_f32 v21, s84, v29
    s_waitcnt lgkmcnt(1)
    v_fmac_f32 v23, s84, v31
    v_fmac_f32 v20, s84, v28
    v_fmac_f32 v22, s84, v30
    v_cvt_pk_bf16_f32 v32, v20, v21
    v_mfma_f32_32x32x16_bf16 v[144:159], a[216:219], a[4:7], v[144:159]
    buffer_load_dwordx4 v243, s[36:39], s63 offen offset:3072 sc1 lds
    s_add_u32 m0, m0, 4096
    s_add_u32 s63, s63, 4096
    v_cvt_pk_bf16_f32 v33, v22, v23
    v_mfma_f32_32x32x16_bf16 v[144:159], a[220:223], a[0:3], v[144:159]
    ds_write_b64 v221, v[32:33] offset:2048
    v_mfma_f32_32x32x16_bf16 v[160:175], a[128:131], a[108:111], 0
    v_mfma_f32_32x32x16_bf16 v[160:175], a[132:135], a[104:107], v[160:175]
    buffer_load_dwordx4 v243, s[36:39], s63 offen offset:0 sc1 lds
    v_mfma_f32_32x32x16_bf16 v[160:175], a[136:139], a[100:103], v[160:175]
    s_waitcnt lgkmcnt(1)
    v_mfma_f32_32x32x16_bf16 v[160:175], a[140:143], a[96:99], v[160:175]
    v_mfma_f32_32x32x16_bf16 v[160:175], a[144:147], a[92:95], v[160:175]
    buffer_load_dwordx4 v243, s[36:39], s63 offen offset:1024 sc1 lds
    v_mfma_f32_32x32x16_bf16 v[160:175], a[148:151], a[88:91], v[160:175]
    v_mfma_f32_32x32x16_bf16 v[160:175], a[152:155], a[84:87], v[160:175]
    v_mfma_f32_32x32x16_bf16 v[160:175], a[156:159], a[80:83], v[160:175]
    buffer_load_dwordx4 v243, s[36:39], s63 offen offset:2048 sc1 lds
    v_permlane16_swap_b32 v151, v159
    v_permlane16_swap_b32 v150, v158
    v_cndmask_b32 v48, v159, v143, s[78:79]
    v_mfma_f32_32x32x16_bf16 v[160:175], a[160:163], a[76:79], v[160:175]
    v_permlane16_swap_b32 v149, v157
    ds_bpermute_b32 v48, v222, v48
    v_mfma_f32_32x32x16_bf16 v[160:175], a[164:167], a[72:75], v[160:175]
    v_add_f32 v151, v151, v158
    v_add_f32 v150, v150, v157
    v_cndmask_b32 v50, v151, v135, s[78:79]
    v_cndmask_b32 v49, v150, v134, s[78:79]
    v_mfma_f32_32x32x16_bf16 v[160:175], a[168:171], a[68:71], v[160:175]
    buffer_load_dwordx4 v243, s[36:39], s63 offen offset:3072 sc1 lds
    s_add_u32 m0, m0, 4096
    s_add_u32 s63, s63, 4096
    ds_bpermute_b32 v50, v223, v50
    v_mfma_f32_32x32x16_bf16 v[160:175], a[172:175], a[64:67], v[160:175]
    ds_bpermute_b32 v49, v223, v49
    v_permlane16_swap_b32 v148, v156
    v_mfma_f32_32x32x16_bf16 v[160:175], a[176:179], a[60:63], v[160:175]
    ds_read_u16_d16_hi v44, v220 offset:5136
    v_permlane16_swap_b32 v147, v155
    ds_read_u16_d16_hi v45, v220 offset:6288
    v_mfma_f32_32x32x16_bf16 v[160:175], a[180:183], a[56:59], v[160:175]
    buffer_load_dwordx4 v243, s[36:39], s63 offen offset:0 sc1 lds
    v_permlane16_swap_b32 v146, v154
    ds_read_u16_d16_hi v46, v220 offset:7440
    v_mfma_f32_32x32x16_bf16 v[160:175], a[184:187], a[52:55], v[160:175]
    v_permlane16_swap_b32 v145, v153
    ds_read_u16_d16_hi v47, v220 offset:8592
    v_mfma_f32_32x32x16_bf16 v[160:175], a[188:191], a[48:51], v[160:175]
    v_permlane16_swap_b32 v144, v152
    v_add_f32 v149, v149, v156
    v_add_f32 v148, v148, v155
    v_add_f32 v147, v147, v154
    v_add_f32 v146, v146, v153
    v_mfma_f32_32x32x16_bf16 v[160:175], a[192:195], a[44:47], v[160:175]
    ds_read_b64_tr_b16 a[224:225], v218 offset:3104
    ds_read_b64_tr_b16 a[226:227], v218 offset:3072
    buffer_load_dwordx4 v243, s[36:39], s63 offen offset:1024 sc1 lds
    v_add_f32 v145, v145, v152
    v_mfma_f32_32x32x16_bf16 v[160:175], a[196:199], a[40:43], v[160:175]
    ds_read_b64_tr_b16 a[228:229], v218 offset:3232
    ds_read_b64_tr_b16 a[230:231], v218 offset:3200
    s_waitcnt lgkmcnt(4)
    v_add_f32 v144, v144, v48
    v_add_f32 v53, v145, v50
    v_add_f32_dpp v55, v145, v147 row_ror:8 row_mask:0xf bank_mask:0xf
    v_mfma_f32_32x32x16_bf16 v[160:175], a[200:203], a[36:39], v[160:175]
    ds_read_b64_tr_b16 a[232:233], v218 offset:3360
    ds_read_b64_tr_b16 a[234:235], v218 offset:3328
    v_add_f32 v52, v144, v49
    v_add_f32_dpp v54, v144, v146 row_ror:8 row_mask:0xf bank_mask:0xf
    v_add_f32_dpp v53, v149, v147 row_ror:8 row_mask:0xf bank_mask:0xc
    v_mfma_f32_32x32x16_bf16 v[160:175], a[204:207], a[32:35], v[160:175]
    ds_read_b64_tr_b16 a[236:237], v218 offset:3488
    ds_read_b64_tr_b16 a[238:239], v218 offset:3456
    buffer_load_dwordx4 v243, s[36:39], s63 offen offset:2048 sc1 lds
    v_add_f32_dpp v55, v151, v149 row_ror:8 row_mask:0xf bank_mask:0xc
    v_mfma_f32_32x32x16_bf16 v[160:175], a[208:211], a[28:31], v[160:175]
    ds_read_b128 a[124:127], v219 offset:992
    v_add_f32_dpp v52, v148, v146 row_ror:8 row_mask:0xf bank_mask:0xc
    v_add_f32_dpp v54, v150, v148 row_ror:8 row_mask:0xf bank_mask:0xc
    v_fmac_f32 v45, s84, v53
    v_fmac_f32 v47, s84, v55
    v_fmac_f32 v44, s84, v52
    v_mfma_f32_32x32x16_bf16 v[160:175], a[212:215], a[24:27], v[160:175]
    ds_read_b128 a[120:123], v219 offset:960
    buffer_load_dwordx4 v243, s[36:39], s63 offen offset:3072 sc1 lds
    s_add_u32 m0, m0, 4096
    s_add_u32 s63, s63, 4096
    v_fmac_f32 v46, s84, v54
    v_cvt_pk_bf16_f32 v56, v44, v45
    v_mfma_f32_32x32x16_bf16 v[160:175], a[216:219], a[20:23], v[160:175]
    ds_read_b128 a[116:119], v219 offset:928
    v_cvt_pk_bf16_f32 v57, v46, v47
    v_mfma_f32_32x32x16_bf16 v[160:175], a[220:223], a[16:19], v[160:175]
    ds_read_b128 a[112:115], v219 offset:896
    s_waitcnt lgkmcnt(3)
    ds_write_b64 v221, v[56:57] offset:2560
    v_mfma_f32_32x32x16_bf16 v[160:175], a[224:227], a[12:15], v[160:175]
    buffer_load_dwordx4 v243, s[36:39], s63 offen offset:0 sc1 lds
    v_mfma_f32_32x32x16_bf16 v[160:175], a[228:231], a[8:11], v[160:175]
    v_mfma_f32_32x32x16_bf16 v[160:175], a[232:235], a[4:7], v[160:175]
    v_mfma_f32_32x32x16_bf16 v[160:175], a[236:239], a[0:3], v[160:175]
    buffer_load_dwordx4 v243, s[36:39], s63 offen offset:1024 sc1 lds
    v_mfma_f32_32x32x16_bf16 v[176:191], a[128:131], a[124:127], 0
    s_waitcnt lgkmcnt(0)
    v_mfma_f32_32x32x16_bf16 v[176:191], a[132:135], a[120:123], v[176:191]
    v_mfma_f32_32x32x16_bf16 v[176:191], a[136:139], a[116:119], v[176:191]
    buffer_load_dwordx4 v243, s[36:39], s63 offen offset:2048 sc1 lds
    v_mfma_f32_32x32x16_bf16 v[176:191], a[140:143], a[112:115], v[176:191]
    v_mfma_f32_32x32x16_bf16 v[176:191], a[144:147], a[108:111], v[176:191]
    v_mfma_f32_32x32x16_bf16 v[176:191], a[148:151], a[104:107], v[176:191]
    buffer_load_dwordx4 v243, s[36:39], s63 offen offset:3072 sc1 lds
    s_add_u32 m0, m0, 4096
    s_add_u32 s63, s63, 4096
    v_permlane16_swap_b32 v167, v175
    v_permlane16_swap_b32 v166, v174
    v_mfma_f32_32x32x16_bf16 v[176:191], a[152:155], a[100:103], v[176:191]
    v_cndmask_b32 v24, v175, v159, s[78:79]
    v_permlane16_swap_b32 v165, v173
    v_mfma_f32_32x32x16_bf16 v[176:191], a[156:159], a[96:99], v[176:191]
    ds_bpermute_b32 v24, v222, v24
    v_add_f32 v167, v167, v174
    v_add_f32 v166, v166, v173
    v_cndmask_b32 v26, v167, v151, s[78:79]
    v_cndmask_b32 v25, v166, v150, s[78:79]
    v_mfma_f32_32x32x16_bf16 v[176:191], a[160:163], a[92:95], v[176:191]
    buffer_load_dwordx4 v243, s[36:39], s63 offen offset:0 sc1 lds
    s_waitcnt lgkmcnt(0)
    s_barrier
    ds_read_b64 v[64:65], v244 offset:0
    ds_read_b64 v[66:67], v244 offset:4096
    v_mfma_f32_32x32x16_bf16 v[176:191], a[164:167], a[88:91], v[176:191]
    ds_read_b64 v[68:69], v244 offset:8192
    ds_read_b64 v[70:71], v244 offset:12288
    s_waitcnt lgkmcnt(2)
    v_perm_b32 v72, v66, v64, s86
    s_waitcnt lgkmcnt(0)
    v_perm_b32 v73, v70, v68, s86
    v_mfma_f32_32x32x16_bf16 v[176:191], a[168:171], a[84:87], v[176:191]
    ds_bpermute_b32 v26, v223, v26
    v_perm_b32 v74, v66, v64, s87
    v_perm_b32 v75, v70, v68, s87
    v_mfma_f32_32x32x16_bf16 v[176:191], a[172:175], a[80:83], v[176:191]
    buffer_store_dwordx4 v[72:75], v243, s[36:39], s48 offen offset:0 sc1
    v_perm_b32 v76, v67, v65, s86
    v_mfma_f32_32x32x16_bf16 v[176:191], a[176:179], a[76:79], v[176:191]
    buffer_load_dwordx4 v243, s[36:39], s63 offen offset:1024 sc1 lds
    v_perm_b32 v77, v71, v69, s86
    v_perm_b32 v78, v67, v65, s87
    v_perm_b32 v79, v71, v69, s87
    v_mfma_f32_32x32x16_bf16 v[176:191], a[180:183], a[72:75], v[176:191]
    buffer_store_dwordx4 v[76:79], v243, s[36:39], s48 offen offset:1024 sc1
    v_mfma_f32_32x32x16_bf16 v[176:191], a[184:187], a[68:71], v[176:191]
    buffer_load_dwordx4 v243, s[36:39], s63 offen offset:2048 sc1 lds
    ds_bpermute_b32 v25, v223, v25
    v_permlane16_swap_b32 v164, v172
    v_mfma_f32_32x32x16_bf16 v[176:191], a[188:191], a[64:67], v[176:191]
    ds_read_u16_d16_hi v20, v220 offset:5264
    v_permlane16_swap_b32 v163, v171
    ds_read_u16_d16_hi v21, v220 offset:6416
    v_mfma_f32_32x32x16_bf16 v[176:191], a[192:195], a[60:63], v[176:191]
    v_permlane16_swap_b32 v162, v170
    ds_read_u16_d16_hi v22, v220 offset:7568
    v_mfma_f32_32x32x16_bf16 v[176:191], a[196:199], a[56:59], v[176:191]
    buffer_load_dwordx4 v243, s[36:39], s63 offen offset:3072 sc1 lds
    s_lshl_b32 s63, s60, 11
    s_add_u32 m0, s63, 135168
    s_add_u32 s63, s63, s3
    s_add_u32 s63, s63, 81920
    v_permlane16_swap_b32 v161, v169
    v_mfma_f32_32x32x16_bf16 v[176:191], a[200:203], a[52:55], v[176:191]
    ds_read_u16_d16_hi v23, v220 offset:8720
    v_permlane16_swap_b32 v160, v168
    v_add_f32 v165, v165, v172
    v_add_f32 v164, v164, v171
    v_add_f32 v163, v163, v170
    v_mfma_f32_32x32x16_bf16 v[176:191], a[204:207], a[48:51], v[176:191]
    v_add_f32 v162, v162, v169
    v_add_f32 v161, v161, v168
    v_add_f32 v160, v160, v24
    s_waitcnt lgkmcnt(1)
    v_add_f32 v29, v161, v26
    v_add_f32_dpp v31, v161, v163 row_ror:8 row_mask:0xf bank_mask:0xf
    v_mfma_f32_32x32x16_bf16 v[176:191], a[208:211], a[44:47], v[176:191]
    ds_read_b64_tr_b16 a[240:241], v218 offset:3616
    ds_read_b64_tr_b16 a[242:243], v218 offset:3584
    buffer_load_dwordx4 v243, s[36:39], s63 offen offset:0 sc1 lds
    v_add_f32 v28, v160, v25
    v_mfma_f32_32x32x16_bf16 v[176:191], a[212:215], a[40:43], v[176:191]
    ds_read_b64_tr_b16 a[244:245], v218 offset:3744
    ds_read_b64_tr_b16 a[246:247], v218 offset:3712
    v_add_f32_dpp v30, v160, v162 row_ror:8 row_mask:0xf bank_mask:0xf
    v_add_f32_dpp v29, v165, v163 row_ror:8 row_mask:0xf bank_mask:0xc
    v_add_f32_dpp v31, v167, v165 row_ror:8 row_mask:0xf bank_mask:0xc
    v_mfma_f32_32x32x16_bf16 v[176:191], a[216:219], a[36:39], v[176:191]
    ds_read_b64_tr_b16 a[248:249], v218 offset:3872
    ds_read_b64_tr_b16 a[250:251], v218 offset:3840
    buffer_load_dwordx4 v243, s[36:39], s63 offen offset:1024 sc1 lds
    s_mul_i32 s63, s60, 33792
    s_add_u32 m0, s63, 0
    v_mfma_f32_32x32x16_bf16 v[176:191], a[220:223], a[32:35], v[176:191]
    ds_read_b64_tr_b16 a[252:253], v218 offset:4000
    s_mul_i32 s63, s60, 4096
    ds_read_b64_tr_b16 a[254:255], v218 offset:3968
    s_add_u32 s63, s63, s3
    s_add_u32 s63, s63, 90112
    buffer_load_dword v60, v225, s[36:39], s89 offen offset:128 sc1
    v_mfma_f32_32x32x16_bf16 v[176:191], a[224:227], a[28:31], v[176:191]
    v_add_f32_dpp v28, v164, v162 row_ror:8 row_mask:0xf bank_mask:0xc
    v_add_f32_dpp v30, v166, v164 row_ror:8 row_mask:0xf bank_mask:0xc
    v_fmac_f32 v21, s84, v29
    s_waitcnt lgkmcnt(4)
    v_fmac_f32 v23, s84, v31
    v_fmac_f32 v20, s84, v28
    v_mfma_f32_32x32x16_bf16 v[176:191], a[228:231], a[24:27], v[176:191]
    v_fmac_f32 v22, s84, v30
    v_cvt_pk_bf16_f32 v32, v20, v21
    v_cvt_pk_bf16_f32 v33, v22, v23
    v_mfma_f32_32x32x16_bf16 v[176:191], a[232:235], a[20:23], v[176:191]
    ds_write_b64 v221, v[32:33] offset:3072
    v_mfma_f32_32x32x16_bf16 v[176:191], a[236:239], a[16:19], v[176:191]
    v_mfma_f32_32x32x16_bf16 v[176:191], a[240:243], a[12:15], v[176:191]
    v_mfma_f32_32x32x16_bf16 v[176:191], a[244:247], a[8:11], v[176:191]
    s_waitcnt lgkmcnt(1)
    v_mfma_f32_32x32x16_bf16 v[176:191], a[248:251], a[4:7], v[176:191]
    v_mfma_f32_32x32x16_bf16 v[176:191], a[252:255], a[0:3], v[176:191]
    s_nop 11
    v_permlane16_swap_b32 v183, v191
    v_permlane16_swap_b32 v182, v190
    v_cndmask_b32 v48, v191, v175, s[78:79]
    v_permlane16_swap_b32 v181, v189
    ds_bpermute_b32 v48, v222, v48
    v_add_f32 v183, v183, v190
    v_add_f32 v182, v182, v189
    v_cndmask_b32 v50, v183, v167, s[78:79]
    v_cndmask_b32 v49, v182, v166, s[78:79]
    ds_bpermute_b32 v50, v223, v50
    ds_bpermute_b32 v49, v223, v49
    v_permlane16_swap_b32 v180, v188
    ds_read_u16_d16_hi v44, v220 offset:5392
    v_permlane16_swap_b32 v179, v187
    ds_read_u16_d16_hi v45, v220 offset:6544
    v_permlane16_swap_b32 v178, v186
    ds_read_u16_d16_hi v46, v220 offset:7696
    v_permlane16_swap_b32 v177, v185
    ds_read_u16_d16_hi v47, v220 offset:8848
    v_permlane16_swap_b32 v176, v184
    v_add_f32 v181, v181, v188
    v_add_f32 v180, v180, v187
    v_add_f32 v179, v179, v186
    v_add_f32 v178, v178, v185
    v_add_f32 v177, v177, v184
    s_waitcnt lgkmcnt(6)
    v_add_f32 v176, v176, v48
    s_waitcnt lgkmcnt(5)
    v_add_f32 v53, v177, v50
    v_add_f32_dpp v55, v177, v179 row_ror:8 row_mask:0xf bank_mask:0xf
    s_waitcnt lgkmcnt(4)
    v_add_f32 v52, v176, v49
    v_add_f32_dpp v54, v176, v178 row_ror:8 row_mask:0xf bank_mask:0xf
    v_add_f32_dpp v53, v181, v179 row_ror:8 row_mask:0xf bank_mask:0xc
    v_add_f32_dpp v55, v183, v181 row_ror:8 row_mask:0xf bank_mask:0xc
    v_add_f32_dpp v52, v180, v178 row_ror:8 row_mask:0xf bank_mask:0xc
    v_add_f32_dpp v54, v182, v180 row_ror:8 row_mask:0xf bank_mask:0xc
    s_waitcnt lgkmcnt(2)
    v_fmac_f32 v45, s84, v53
    s_waitcnt lgkmcnt(0)
    v_fmac_f32 v47, s84, v55
    v_fmac_f32 v44, s84, v52
    v_fmac_f32 v46, s84, v54
    v_cvt_pk_bf16_f32 v56, v44, v45
    v_cvt_pk_bf16_f32 v57, v46, v47
    ds_write_b64 v221, v[56:57] offset:3584
    s_waitcnt vmcnt(0)
    v_cmp_ne_u32 s[56:57], s34, v60
    s_nop 1
    s_cmp_lg_u64 s[56:57], 0
    s_cbranch_scc0 F_h4
    s_mov_b32 s97, 0
F_h4_l:
    s_sleep 1
    buffer_load_dword v60, v225, s[36:39], s89 offen offset:128 sc1
    s_add_u32 s97, s97, 1
    s_waitcnt vmcnt(0)
    v_cmp_ne_u32 s[56:57], s34, v60
    s_nop 1
    s_cmp_lg_u64 s[56:57], 0
    s_cbranch_scc0 F_h4
    s_cmp_lt_u32 s97, 0x40000
    s_cbranch_scc1 F_h4_l
F_h4:
    s_waitcnt lgkmcnt(0)
    s_barrier
    ds_read_b64 v[80:81], v244 offset:2048
    ds_read_b64 v[82:83], v244 offset:6144
    ds_read_b64 v[84:85], v244 offset:10240
    ds_read_b64 v[86:87], v244 offset:14336
    s_waitcnt lgkmcnt(2)
    v_perm_b32 v88, v82, v80, s86
    s_waitcnt lgkmcnt(0)
    v_perm_b32 v89, v86, v84, s86
    v_perm_b32 v90, v82, v80, s87
    v_perm_b32 v91, v86, v84, s87
    buffer_store_dwordx4 v[88:91], v243, s[36:39], s49 offen offset:0 sc1
    v_perm_b32 v92, v83, v81, s86
    v_perm_b32 v93, v87, v85, s86
    v_perm_b32 v94, v83, v81, s87
    v_perm_b32 v95, v87, v85, s87
    buffer_store_dwordx4 v[92:95], v243, s[36:39], s49 offen offset:1024 sc1
    v_lshlrev_b32 v3, 4, v1
F_g1x:
    v_lshrrev_b32 v5, 4, v1
    v_and_b32 v6, 15, v1
    v_lshlrev_b32 v7, 15, v5
    v_lshl_add_u32 v7, v6, 4, v7
    v_lshlrev_b32 v3, 4, v1
    s_lshl2_add_u32 s78, s92, s60
    s_lshl_b32 s78, s78, 8
    s_add_u32 s78, s78, 0x600000
    s_add_u32 s79, s78, 16384
    s_mov_b32 s64, s78
    s_cmp_lt_u32 s62, 20
    s_cbranch_scc1 F_can
    s_mov_b32 s97, 0
F_canl:
    buffer_load_dwordx4 v[96:99], v7, s[36:39], s78 offen sc1
    s_add_u32 s97, s97, 1
    s_waitcnt vmcnt(0)
    v_cmp_eq_u32 vcc, -1, v96
    s_nop 4
    s_cbranch_vccz F_can
    s_sleep 4
    s_cmp_lt_u32 s97, 0x40000
    s_cbranch_scc1 F_canl
F_can:
    buffer_load_dwordx4 v[96:99], v7, s[36:39], s78 offen sc1
    buffer_load_dwordx4 v[100:103], v7, s[36:39], s79 offen sc1
    s_add_u32 s78, s78, 0x20000
    s_add_u32 s79, s79, 0x20000
    buffer_load_dwordx4 v[104:107], v7, s[36:39], s78 offen sc1
    buffer_load_dwordx4 v[108:111], v7, s[36:39], s79 offen sc1
    s_add_u32 s78, s78, 0x20000
    s_add_u32 s79, s79, 0x20000
    buffer_load_dwordx4 v[112:115], v7, s[36:39], s78 offen sc1
    buffer_load_dwordx4 v[116:119], v7, s[36:39], s79 offen sc1
    s_add_u32 s78, s78, 0x20000
    s_add_u32 s79, s79, 0x20000
    buffer_load_dwordx4 v[120:123], v7, s[36:39], s78 offen sc1
    buffer_load_dwordx4 v[124:127], v7, s[36:39], s79 offen sc1
    s_add_u32 s78, s78, 0x20000
    s_add_u32 s79, s79, 0x20000
    buffer_load_dwordx4 v[128:131], v7, s[36:39], s78 offen sc1
    buffer_load_dwordx4 v[132:135], v7, s[36:39], s79 offen sc1
    s_add_u32 s78, s78, 0x20000
    s_add_u32 s79, s79, 0x20000
    buffer_load_dwordx4 v[136:139], v7, s[36:39], s78 offen sc1
    buffer_load_dwordx4 v[140:143], v7, s[36:39], s79 offen sc1
    s_add_u32 s78, s78, 0x20000
    s_add_u32 s79, s79, 0x20000
    buffer_load_dwordx4 v[144:147], v7, s[36:39], s78 offen sc1
    buffer_load_dwordx4 v[148:151], v7, s[36:39], s79 offen sc1
    s_add_u32 s78, s78, 0x20000
    s_add_u32 s79, s79, 0x20000
    v_add_u32 v4, 0xe000, v3
    v_lshlrev_b32 v10, 4, v5
    v_add_u32 v5, 0x1c000, v3
    v_and_b32 v8, 3, v6
    v_cmp_eq_u32 s[68:69], 1, v8
    v_cmp_eq_u32 s[70:71], 2, v8
    v_cmp_eq_u32 s[72:73], 3, v8
    v_lshrrev_b32 v8, 2, v6
    v_lshl_add_u32 v8, v8, 4, v6
    v_lshlrev_b32 v8, 2, v8
    v_add_u32 v9, 48, v6
    v_lshlrev_b32 v9, 2, v9
    s_mul_i32 s65, s60, 896
    s_add_u32 s50, s65, 160256
    v_add_u32 v10, s50, v10
    v_bfe_u32 v12, v3, 8, 1
    v_lshrrev_b32 v13, 9, v3
    v_mul_u32_u24 v12, 57344, v12
    v_lshl_add_u32 v12, v13, 9, v12
    v_lshl_add_u32 v6, v6, 4, v12
    s_mov_b32 s51, 0x7f000000
    s_mov_b32 s52, 0xffff0000
    s_mov_b32 s53, 0xffff0000
    s_lshl_b32 s65, s92, 3
    s_lshl1_add_u32 s65, s60, s65
    s_mul_i32 s65, s65, 56
    s_lshr_b32 s66, s93, 1
    s_mul_i32 s66, s66, 7
    s_add_u32 s65, s65, s66
    s_and_b32 s66, s93, 1
    s_lshl_b32 s67, s66, 3
    s_mul_i32 s66, s66, 3
    s_add_u32 s74, s65, s66
    s_lshl_b32 s74, s74, 10
    s_add_u32 s74, s74, 0x1000000
    s_add_u32 s75, s74, 57344
    s_add_u32 s76, s65, 6
    s_lshl_b32 s76, s76, 10
    s_add_u32 s76, s76, s67
    s_add_u32 s76, s76, 0x1000000
    s_add_u32 s77, s76, 57344
    s_mul_i32 s99, s95, 286720
    s_mul_i32 s98, s60, 71680
    s_add_u32 s99, s99, s98
    s_add_u32 s99, s99, 0xc00000
    s_add_u32 s65, s88, 1
    s_and_b32 s65, s65, 3
    s_mul_i32 s84, s65, 15360
    s_lshl2_add_u32 s65, s94, s65
    s_mul_i32 s65, s65, 56
    s_mul_i32 s66, s60, 14
    s_add_u32 s65, s65, s66
    s_lshl_b32 s65, s65, 10
    s_add_u32 s80, s65, 0x1000000
    s_add_u32 s65, s88, 2
    s_and_b32 s65, s65, 3
    s_mul_i32 s85, s65, 15360
    s_lshl2_add_u32 s65, s94, s65
    s_mul_i32 s65, s65, 56
    s_mul_i32 s66, s60, 14
    s_add_u32 s65, s65, s66
    s_lshl_b32 s65, s65, 10
    s_add_u32 s81, s65, 0x1000000
    s_add_u32 s65, s88, 3
    s_and_b32 s65, s65, 3
    s_mul_i32 s86, s65, 15360
    s_lshl2_add_u32 s65, s94, s65
    s_mul_i32 s65, s65, 56
    s_mul_i32 s66, s60, 14
    s_add_u32 s65, s65, s66
    s_lshl_b32 s65, s65, 10
    s_add_u32 s82, s65, 0x1000000
    s_add_u32 s65, s88, 4
    s_and_b32 s65, s65, 3
    s_mul_i32 s87, s65, 15360
    s_lshl2_add_u32 s65, s94, s65
    s_mul_i32 s65, s65, 56
    s_mul_i32 s66, s60, 14
    s_add_u32 s65, s65, s66
    s_lshl_b32 s65, s65, 10
    s_add_u32 s83, s65, 0x1000000
    s_sub_u32 s65, s93, s61
    s_lshl_b32 s65, s65, 9
    s_add_u32 s65, s65, 128
    v_and_b32 v20, 1, v1
    v_mul_lo_u32 v20, v20, s65
    v_add_u32 v20, s89, v20
    s_mov_b32 s89, 0
    s_mul_i32 s40, s92, 3072
    s_lshl2_add_u32 s40, s93, s40
    s_add_u32 s40, s40, 0x26000
    s_cmp_eq_u32 s60, 0
    s_cselect_b32 s40, s40, 0x7f000000
    s_add_u32 s41, s40, 1024
    s_add_u32 s42, s40, 2048
    s_lshr_b32 s44, s94, 1
    s_mul_i32 s44, s44, 3072
    s_and_b32 s45, s94, 1
    s_lshl3_add_u32 s45, s45, s95
    s_lshl2_add_u32 s45, s45, s60
    s_lshl4_add_u32 s44, s45, s44
    s_add_u32 s44, s44, 0x26000
    s_add_u32 s45, s44, 1024
    s_add_u32 s46, s44, 2048
    v_mov_b32 v11, 0x7f000000
    v_lshlrev_b32 v0, 6, v1
    v_cmp_gt_u32 vcc, 16, v1
    s_nop 1
    v_cndmask_b32 v0, v11, v0, vcc
    v_cmp_gt_u32 vcc, 4, v1
    v_lshlrev_b32 v1, 2, v1
    s_nop 0
    v_cndmask_b32 v1, v11, v1, vcc
    ds_read_b128 a[0:3], v3 offset:13312
    ds_read_b128 a[4:7], v3 offset:14336
    ds_read_b128 a[8:11], v3 offset:15360
    ds_read_b128 a[12:15], v3 offset:16384
    ds_read_b128 a[16:19], v3 offset:17408
    s_waitcnt vmcnt(11)
    v_max3_u32 v11, v96, v100, v104
    s_waitcnt vmcnt(10)
    v_max_u32 v11, v11, v108
    v_cmp_eq_u32 vcc, -1, v11
    s_nop 4
    s_cbranch_vccnz Lx0
Lx0_b:
    v_swap_b32 v98, v100
    v_swap_b32 v99, v101
    s_waitcnt lgkmcnt(4)
    s_nop 0
    v_mfma_f32_16x16x32_bf16 v[80:83], a[0:3], v[96:99], 0
    ds_read_b128 a[20:23], v3 offset:18432
    v_mfma_f32_16x16x32_bf16 v[84:87], a[0:3], v[100:103], 0
    buffer_load_dwordx4 v[152:155], v7, s[36:39], s78 offen sc1
    s_waitcnt lgkmcnt(4)
    v_mfma_f32_16x16x32_bf16 v[32:35], a[4:7], v[96:99], 0
    ds_read_b128 a[24:27], v3 offset:19456
    v_mfma_f32_16x16x32_bf16 v[36:39], a[4:7], v[100:103], 0
    buffer_load_dwordx4 v[156:159], v7, s[36:39], s79 offen sc1
    s_waitcnt lgkmcnt(4)
    s_add_u32 s78, s78, 0x20000
    v_mfma_f32_16x16x32_bf16 v[40:43], a[8:11], v[96:99], 0
    ds_read_b128 a[28:31], v3 offset:20480
    s_add_u32 s79, s79, 0x20000
    v_mfma_f32_16x16x32_bf16 v[44:47], a[8:11], v[100:103], 0
    v_swap_b32 v106, v108
    v_mfma_f32_16x16x32_bf16 v[88:91], v[96:99], v[96:99], 0
    v_swap_b32 v107, v109
    v_mfma_f32_16x16x32_bf16 v[92:95], v[100:103], v[100:103], 0
    s_waitcnt lgkmcnt(2)
    s_waitcnt vmcnt(9)
    v_max3_u32 v11, v112, v116, v120
    v_mfma_f32_16x16x32_bf16 v[80:83], a[12:15], v[104:107], v[80:83]
    ds_read_b128 a[0:3], v3 offset:21504
    s_waitcnt vmcnt(8)
    v_max_u32 v11, v11, v124
    v_mfma_f32_16x16x32_bf16 v[84:87], a[12:15], v[108:111], v[84:87]
    buffer_load_dwordx4 v[160:163], v7, s[36:39], s78 offen sc1
    v_cmp_eq_u32 vcc, -1, v11
    v_mfma_f32_16x16x32_bf16 v[32:35], a[16:19], v[104:107], v[32:35]
    ds_read_b128 a[4:7], v3 offset:22528
    v_mfma_f32_16x16x32_bf16 v[36:39], a[16:19], v[108:111], v[36:39]
    buffer_load_dwordx4 v[164:167], v7, s[36:39], s79 offen sc1
    s_add_u32 s78, s78, 0x20000
    s_add_u32 s79, s79, 0x20000
    v_mfma_f32_16x16x32_bf16 v[40:43], a[20:23], v[104:107], v[40:43]
    ds_read_b128 a[8:11], v3 offset:23552
    s_cbranch_vccnz Lx2
Lx2_b:
    v_mfma_f32_16x16x32_bf16 v[44:47], a[20:23], v[108:111], v[44:47]
    v_swap_b32 v114, v116
    v_mfma_f32_16x16x32_bf16 v[88:91], v[104:107], v[104:107], v[88:91]
    v_swap_b32 v115, v117
    v_mfma_f32_16x16x32_bf16 v[92:95], v[108:111], v[108:111], v[92:95]
    s_waitcnt lgkmcnt(2)
    v_mfma_f32_16x16x32_bf16 v[80:83], a[24:27], v[112:115], v[80:83]
    ds_read_b128 a[12:15], v3 offset:24576
    v_mfma_f32_16x16x32_bf16 v[84:87], a[24:27], v[116:119], v[84:87]
    buffer_load_dwordx4 v[168:171], v7, s[36:39], s78 offen sc1
    v_mfma_f32_16x16x32_bf16 v[32:35], a[28:31], v[112:115], v[32:35]
    ds_read_b128 a[16:19], v3 offset:25600
    v_mfma_f32_16x16x32_bf16 v[36:39], a[28:31], v[116:119], v[36:39]
    buffer_load_dwordx4 v[172:175], v7, s[36:39], s79 offen sc1
    s_add_u32 s78, s78, 0x20000
    s_add_u32 s79, s79, 0x20000
    v_mfma_f32_16x16x32_bf16 v[40:43], a[0:3], v[112:115], v[40:43]
    ds_read_b128 a[20:23], v3 offset:26624
    v_mfma_f32_16x16x32_bf16 v[44:47], a[0:3], v[116:119], v[44:47]
    v_swap_b32 v122, v124
    v_mfma_f32_16x16x32_bf16 v[88:91], v[112:115], v[112:115], v[88:91]
    v_swap_b32 v123, v125
    v_mfma_f32_16x16x32_bf16 v[92:95], v[116:119], v[116:119], v[92:95]
    s_waitcnt lgkmcnt(2)
    s_waitcnt vmcnt(9)
    v_max3_u32 v11, v128, v132, v136
    v_mfma_f32_16x16x32_bf16 v[80:83], a[4:7], v[120:123], v[80:83]
    ds_read_b128 a[24:27], v3 offset:27648
    s_waitcnt vmcnt(8)
    v_max_u32 v11, v11, v140
    v_mfma_f32_16x16x32_bf16 v[84:87], a[4:7], v[124:127], v[84:87]
    buffer_load_dwordx4 v[176:179], v7, s[36:39], s78 offen sc1
    v_cmp_eq_u32 vcc, -1, v11
    v_mfma_f32_16x16x32_bf16 v[32:35], a[8:11], v[120:123], v[32:35]
    ds_read_b128 a[28:31], v3 offset:28672
    v_mfma_f32_16x16x32_bf16 v[36:39], a[8:11], v[124:127], v[36:39]
    buffer_load_dwordx4 v[180:183], v7, s[36:39], s79 offen sc1
    s_add_u32 s78, s78, 0x20000
    s_add_u32 s79, s79, 0x20000
    v_mfma_f32_16x16x32_bf16 v[40:43], a[12:15], v[120:123], v[40:43]
    ds_read_b128 a[0:3], v3 offset:29696
    s_cbranch_vccnz Lx4
Lx4_b:
    v_mfma_f32_16x16x32_bf16 v[44:47], a[12:15], v[124:127], v[44:47]
    v_swap_b32 v130, v132
    v_mfma_f32_16x16x32_bf16 v[88:91], v[120:123], v[120:123], v[88:91]
    v_swap_b32 v131, v133
    v_mfma_f32_16x16x32_bf16 v[92:95], v[124:127], v[124:127], v[92:95]
    s_waitcnt lgkmcnt(2)
    v_mfma_f32_16x16x32_bf16 v[80:83], a[16:19], v[128:131], v[80:83]
    ds_read_b128 a[4:7], v3 offset:30720
    v_mfma_f32_16x16x32_bf16 v[84:87], a[16:19], v[132:135], v[84:87]
    buffer_load_dwordx4 v[184:187], v7, s[36:39], s78 offen sc1
    v_mfma_f32_16x16x32_bf16 v[32:35], a[20:23], v[128:131], v[32:35]
    ds_read_b128 a[8:11], v3 offset:31744
    v_mfma_f32_16x16x32_bf16 v[36:39], a[20:23], v[132:135], v[36:39]
    buffer_load_dwordx4 v[188:191], v7, s[36:39], s79 offen sc1
    s_add_u32 s78, s78, 0x20000
    s_add_u32 s79, s79, 0x20000
    v_mfma_f32_16x16x32_bf16 v[40:43], a[24:27], v[128:131], v[40:43]
    ds_read_b128 a[12:15], v3 offset:32768
    v_mfma_f32_16x16x32_bf16 v[44:47], a[24:27], v[132:135], v[44:47]
    v_swap_b32 v138, v140
    v_mfma_f32_16x16x32_bf16 v[88:91], v[128:131], v[128:131], v[88:91]
    v_swap_b32 v139, v141
    v_mfma_f32_16x16x32_bf16 v[92:95], v[132:135], v[132:135], v[92:95]
    s_waitcnt lgkmcnt(2)
    s_waitcnt vmcnt(9)
    v_max3_u32 v11, v144, v148, v152
    v_mfma_f32_16x16x32_bf16 v[80:83], a[28:31], v[136:139], v[80:83]
    ds_read_b128 a[16:19], v3 offset:47104
    s_waitcnt vmcnt(8)
    v_max_u32 v11, v11, v156
    v_mfma_f32_16x16x32_bf16 v[84:87], a[28:31], v[140:143], v[84:87]
    buffer_load_dwordx4 v[192:195], v7, s[36:39], s78 offen sc1
    v_cmp_eq_u32 vcc, -1, v11
    v_mfma_f32_16x16x32_bf16 v[32:35], a[0:3], v[136:139], v[32:35]
    ds_read_b128 a[20:23], v3 offset:48128
    v_mfma_f32_16x16x32_bf16 v[36:39], a[0:3], v[140:143], v[36:39]
    buffer_load_dwordx4 v[196:199], v7, s[36:39], s79 offen sc1
    s_add_u32 s78, s78, 0x20000
    s_add_u32 s79, s79, 0x20000
    v_mfma_f32_16x16x32_bf16 v[40:43], a[4:7], v[136:139], v[40:43]
    ds_read_b128 a[24:27], v3 offset:49152
    s_cbranch_vccnz Lx6
Lx6_b:
    v_mfma_f32_16x16x32_bf16 v[44:47], a[4:7], v[140:143], v[44:47]
    v_swap_b32 v146, v148
    v_mfma_f32_16x16x32_bf16 v[88:91], v[136:139], v[136:139], v[88:91]
    v_swap_b32 v147, v149
    v_mfma_f32_16x16x32_bf16 v[92:95], v[140:143], v[140:143], v[92:95]
    s_waitcnt lgkmcnt(2)
    v_mfma_f32_16x16x32_bf16 v[80:83], a[8:11], v[144:147], v[80:83]
    ds_read_b128 a[28:31], v3 offset:50176
    v_mfma_f32_16x16x32_bf16 v[84:87], a[8:11], v[148:151], v[84:87]
    buffer_load_dwordx4 v[200:203], v7, s[36:39], s78 offen sc1
    v_mfma_f32_16x16x32_bf16 v[32:35], a[12:15], v[144:147], v[32:35]
    ds_read_b128 a[0:3], v3 offset:51200
    v_mfma_f32_16x16x32_bf16 v[36:39], a[12:15], v[148:151], v[36:39]
    buffer_load_dwordx4 v[204:207], v7, s[36:39], s79 offen sc1
    s_add_u32 s78, s78, 0x20000
    s_add_u32 s79, s79, 0x20000
    v_mfma_f32_16x16x32_bf16 v[40:43], a[16:19], v[144:147], v[40:43]
    ds_read_b128 a[4:7], v3 offset:52224
    v_mfma_f32_16x16x32_bf16 v[44:47], a[16:19], v[148:151], v[44:47]
    v_swap_b32 v154, v156
    v_mfma_f32_16x16x32_bf16 v[88:91], v[144:147], v[144:147], v[88:91]
    v_swap_b32 v155, v157
    v_mfma_f32_16x16x32_bf16 v[92:95], v[148:151], v[148:151], v[92:95]
    s_waitcnt lgkmcnt(2)
    s_waitcnt vmcnt(9)
    v_max3_u32 v11, v160, v164, v168
    v_mfma_f32_16x16x32_bf16 v[80:83], a[20:23], v[152:155], v[80:83]
    ds_read_b128 a[8:11], v3 offset:53248
    s_waitcnt vmcnt(8)
    v_max_u32 v11, v11, v172
    v_mfma_f32_16x16x32_bf16 v[84:87], a[20:23], v[156:159], v[84:87]
    buffer_load_dwordx4 v[208:211], v7, s[36:39], s78 offen sc1
    v_cmp_eq_u32 vcc, -1, v11
    v_mfma_f32_16x16x32_bf16 v[32:35], a[24:27], v[152:155], v[32:35]
    ds_read_b128 a[12:15], v3 offset:54272
    v_mfma_f32_16x16x32_bf16 v[36:39], a[24:27], v[156:159], v[36:39]
    buffer_load_dwordx4 v[212:215], v7, s[36:39], s79 offen sc1
    s_add_u32 s78, s78, 0x20000
    s_add_u32 s79, s79, 0x20000
    v_mfma_f32_16x16x32_bf16 v[40:43], a[28:31], v[152:155], v[40:43]
    ds_read_b128 a[16:19], v3 offset:55296
    s_cbranch_vccnz Lx8
Lx8_b:
    v_mfma_f32_16x16x32_bf16 v[44:47], a[28:31], v[156:159], v[44:47]
    v_swap_b32 v162, v164
    v_mfma_f32_16x16x32_bf16 v[88:91], v[152:155], v[152:155], v[88:91]
    v_swap_b32 v163, v165
    v_mfma_f32_16x16x32_bf16 v[92:95], v[156:159], v[156:159], v[92:95]
    s_waitcnt lgkmcnt(2)
    v_mfma_f32_16x16x32_bf16 v[80:83], a[0:3], v[160:163], v[80:83]
    ds_read_b128 a[20:23], v3 offset:56320
    v_mfma_f32_16x16x32_bf16 v[84:87], a[0:3], v[164:167], v[84:87]
    buffer_load_dwordx4 v[216:219], v7, s[36:39], s78 offen sc1
    v_mfma_f32_16x16x32_bf16 v[32:35], a[4:7], v[160:163], v[32:35]
    ds_read_b128 a[24:27], v4 offset:0
    v_mfma_f32_16x16x32_bf16 v[36:39], a[4:7], v[164:167], v[36:39]
    buffer_load_dwordx4 v[220:223], v7, s[36:39], s79 offen sc1
    s_add_u32 s78, s78, 0x20000
    s_add_u32 s79, s79, 0x20000
    v_mfma_f32_16x16x32_bf16 v[40:43], a[8:11], v[160:163], v[40:43]
    ds_read_b128 a[28:31], v4 offset:1024
    v_mfma_f32_16x16x32_bf16 v[44:47], a[8:11], v[164:167], v[44:47]
    v_swap_b32 v170, v172
    v_mfma_f32_16x16x32_bf16 v[88:91], v[160:163], v[160:163], v[88:91]
    buffer_load_dword v16, v20, s[36:39], s89 offen offset:256 sc1
    v_swap_b32 v171, v173
    v_mfma_f32_16x16x32_bf16 v[92:95], v[164:167], v[164:167], v[92:95]
    s_waitcnt lgkmcnt(2)
    s_waitcnt vmcnt(10)
    v_max3_u32 v11, v176, v180, v184
    v_mfma_f32_16x16x32_bf16 v[80:83], a[12:15], v[168:171], v[80:83]
    ds_read_b128 a[0:3], v4 offset:2048
    s_waitcnt vmcnt(9)
    v_max_u32 v11, v11, v188
    v_mfma_f32_16x16x32_bf16 v[84:87], a[12:15], v[172:175], v[84:87]
    buffer_load_dwordx4 v[224:227], v7, s[36:39], s78 offen sc1
    v_cmp_eq_u32 vcc, -1, v11
    v_mfma_f32_16x16x32_bf16 v[32:35], a[16:19], v[168:171], v[32:35]
    ds_read_b128 a[4:7], v4 offset:3072
    v_mfma_f32_16x16x32_bf16 v[36:39], a[16:19], v[172:175], v[36:39]
    buffer_load_dwordx4 v[228:231], v7, s[36:39], s79 offen sc1
    s_add_u32 s78, s78, 0x20000
    s_add_u32 s79, s79, 0x20000
    v_mfma_f32_16x16x32_bf16 v[40:43], a[20:23], v[168:171], v[40:43]
    ds_read_b128 a[8:11], v4 offset:4096
    s_cbranch_vccnz Lx10
Lx10_b:
    v_mfma_f32_16x16x32_bf16 v[44:47], a[20:23], v[172:175], v[44:47]
    v_swap_b32 v178, v180
    v_mfma_f32_16x16x32_bf16 v[88:91], v[168:171], v[168:171], v[88:91]
    v_swap_b32 v179, v181
    v_mfma_f32_16x16x32_bf16 v[92:95], v[172:175], v[172:175], v[92:95]
    s_waitcnt lgkmcnt(2)
    v_mfma_f32_16x16x32_bf16 v[80:83], a[24:27], v[176:179], v[80:83]
    ds_read_b128 a[12:15], v4 offset:5120
    v_mfma_f32_16x16x32_bf16 v[84:87], a[24:27], v[180:183], v[84:87]
    buffer_load_dwordx4 v[232:235], v7, s[36:39], s78 offen sc1
    v_mfma_f32_16x16x32_bf16 v[32:35], a[28:31], v[176:179], v[32:35]
    ds_read_b128 a[16:19], v4 offset:6144
    v_mfma_f32_16x16x32_bf16 v[36:39], a[28:31], v[180:183], v[36:39]
    buffer_load_dwordx4 v[236:239], v7, s[36:39], s79 offen sc1
    s_add_u32 s78, s78, 0x20000
    s_add_u32 s79, s79, 0x20000
    v_mfma_f32_16x16x32_bf16 v[40:43], a[0:3], v[176:179], v[40:43]
    ds_read_b128 a[20:23], v4 offset:7168
    v_mfma_f32_16x16x32_bf16 v[44:47], a[0:3], v[180:183], v[44:47]
    v_swap_b32 v186, v188
    v_mfma_f32_16x16x32_bf16 v[88:91], v[176:179], v[176:179], v[88:91]
    v_swap_b32 v187, v189
    v_mfma_f32_16x16x32_bf16 v[92:95], v[180:183], v[180:183], v[92:95]
    s_waitcnt lgkmcnt(2)
    s_waitcnt vmcnt(10)
    v_max3_u32 v11, v192, v196, v200
    v_mfma_f32_16x16x32_bf16 v[80:83], a[4:7], v[184:187], v[80:83]
    ds_read_b128 a[24:27], v4 offset:8192
    s_waitcnt vmcnt(9)
    v_max_u32 v11, v11, v204
    v_mfma_f32_16x16x32_bf16 v[84:87], a[4:7], v[188:191], v[84:87]
    buffer_load_dwordx4 v[240:243], v7, s[36:39], s78 offen sc1
    v_cmp_eq_u32 vcc, -1, v11
    v_mfma_f32_16x16x32_bf16 v[32:35], a[8:11], v[184:187], v[32:35]
    ds_read_b128 a[28:31], v4 offset:9216
    v_mfma_f32_16x16x32_bf16 v[36:39], a[8:11], v[188:191], v[36:39]
    buffer_load_dwordx4 v[244:247], v7, s[36:39], s79 offen sc1
    s_add_u32 s78, s78, 0x20000
    s_add_u32 s79, s79, 0x20000
    v_mfma_f32_16x16x32_bf16 v[40:43], a[12:15], v[184:187], v[40:43]
    ds_read_b128 a[0:3], v4 offset:23552
    s_cbranch_vccnz Lx12
Lx12_b:
    v_mfma_f32_16x16x32_bf16 v[44:47], a[12:15], v[188:191], v[44:47]
    v_swap_b32 v194, v196
    v_mfma_f32_16x16x32_bf16 v[88:91], v[184:187], v[184:187], v[88:91]
    v_swap_b32 v195, v197
    v_mfma_f32_16x16x32_bf16 v[92:95], v[188:191], v[188:191], v[92:95]
    s_waitcnt lgkmcnt(2)
    v_mfma_f32_16x16x32_bf16 v[80:83], a[16:19], v[192:195], v[80:83]
    ds_read_b128 a[4:7], v4 offset:24576
    v_mfma_f32_16x16x32_bf16 v[84:87], a[16:19], v[196:199], v[84:87]
    buffer_load_dwordx4 v[248:251], v7, s[36:39], s78 offen sc1
    v_mfma_f32_16x16x32_bf16 v[32:35], a[20:23], v[192:195], v[32:35]
    ds_read_b128 a[8:11], v4 offset:25600
    v_mfma_f32_16x16x32_bf16 v[36:39], a[20:23], v[196:199], v[36:39]
    buffer_load_dwordx4 v[252:255], v7, s[36:39], s79 offen sc1
    v_mfma_f32_16x16x32_bf16 v[40:43], a[24:27], v[192:195], v[40:43]
    ds_read_b128 a[12:15], v4 offset:26624
    v_mfma_f32_16x16x32_bf16 v[44:47], a[24:27], v[196:199], v[44:47]
    v_swap_b32 v202, v204
    v_mfma_f32_16x16x32_bf16 v[88:91], v[192:195], v[192:195], v[88:91]
    v_swap_b32 v203, v205
    v_mfma_f32_16x16x32_bf16 v[92:95], v[196:199], v[196:199], v[92:95]
    s_waitcnt lgkmcnt(2)
    s_waitcnt vmcnt(10)
    v_max3_u32 v11, v208, v212, v216
    v_mfma_f32_16x16x32_bf16 v[80:83], a[28:31], v[200:203], v[80:83]
    ds_read_b128 a[16:19], v4 offset:27648
    s_waitcnt vmcnt(9)
    v_max_u32 v11, v11, v220
    v_mfma_f32_16x16x32_bf16 v[84:87], a[28:31], v[204:207], v[84:87]
    v_cmp_eq_u32 vcc, -1, v11
    v_mfma_f32_16x16x32_bf16 v[32:35], a[0:3], v[200:203], v[32:35]
    ds_read_b128 a[20:23], v4 offset:28672
    v_mfma_f32_16x16x32_bf16 v[36:39], a[0:3], v[204:207], v[36:39]
    buffer_load_dwordx4 v3, s[36:39], s63 offen offset:0 sc1 lds
    v_mfma_f32_16x16x32_bf16 v[40:43], a[4:7], v[200:203], v[40:43]
    ds_read_b128 a[24:27], v4 offset:29696
    s_cbranch_vccnz Lx14
Lx14_b:
    v_mfma_f32_16x16x32_bf16 v[44:47], a[4:7], v[204:207], v[44:47]
    v_swap_b32 v210, v212
    v_mfma_f32_16x16x32_bf16 v[88:91], v[200:203], v[200:203], v[88:91]
    v_swap_b32 v211, v213
    v_mfma_f32_16x16x32_bf16 v[92:95], v[204:207], v[204:207], v[92:95]
    buffer_load_dwordx4 v3, s[36:39], s63 offen offset:1024 sc1 lds
    s_waitcnt lgkmcnt(2)
    v_mfma_f32_16x16x32_bf16 v[80:83], a[8:11], v[208:211], v[80:83]
    ds_read_b128 a[28:31], v4 offset:30720
    s_waitcnt vmcnt(10)
    v_cmp_ne_u32 s[56:57], s34, v16
    v_mfma_f32_16x16x32_bf16 v[84:87], a[8:11], v[212:215], v[84:87]
    v_mfma_f32_16x16x32_bf16 v[32:35], a[12:15], v[208:211], v[32:35]
    ds_read_b128 a[0:3], v4 offset:31744
    s_cmp_lg_u64 s[56:57], 0
    s_cbranch_scc0 F_h5
    s_mov_b32 s97, 0
F_h5_l:
    s_sleep 1
    buffer_load_dword v16, v20, s[36:39], s89 offen offset:256 sc1
    s_add_u32 s97, s97, 1
    s_waitcnt vmcnt(0)
    v_cmp_ne_u32 s[56:57], s34, v16
    s_nop 1
    s_cmp_lg_u64 s[56:57], 0
    s_cbranch_scc0 F_h5
    s_cmp_lt_u32 s97, 0x40000
    s_cbranch_scc1 F_h5_l
F_h5:
    v_mfma_f32_16x16x32_bf16 v[36:39], a[12:15], v[212:215], v[36:39]
    s_mov_b32 s67, m0
    s_mul_i32 s66, s60, 896
    s_add_u32 m0, s66, 160256
    s_lshl_b32 s66, s93, 10
    s_add_u32 s66, s66, 0x50000
    s_mov_b32 exec_hi, 0xffffff
    buffer_load_dwordx4 v3, s[36:39], s66 offen sc1 lds
    s_mov_b32 exec_hi, -1
    s_mov_b32 m0, s67
    v_mfma_f32_16x16x32_bf16 v[40:43], a[16:19], v[208:211], v[40:43]
    ds_read_b128 a[4:7], v4 offset:32768
    v_mfma_f32_16x16x32_bf16 v[44:47], a[16:19], v[212:215], v[44:47]
    buffer_load_dwordx4 v3, s[36:39], s63 offen offset:2048 sc1 lds
    v_mfma_f32_16x16x32_bf16 v[88:91], v[208:211], v[208:211], v[88:91]
    v_swap_b32 v218, v220
    v_swap_b32 v219, v221
    v_mfma_f32_16x16x32_bf16 v[92:95], v[212:215], v[212:215], v[92:95]
    s_waitcnt lgkmcnt(1)
    s_waitcnt vmcnt(9)
    v_max3_u32 v11, v224, v228, v232
    v_mfma_f32_16x16x32_bf16 v[80:83], a[20:23], v[216:219], v[80:83]
    ds_read_b128 a[8:11], v4 offset:33792
    s_waitcnt vmcnt(8)
    v_max_u32 v11, v11, v236
    v_mfma_f32_16x16x32_bf16 v[84:87], a[20:23], v[220:223], v[84:87]
    buffer_load_dwordx4 v3, s[36:39], s63 offen offset:3072 sc1 lds
    s_mul_i32 s63, s60, 33792
    s_add_u32 m0, s63, 9216
    v_mfma_f32_16x16x32_bf16 v[32:35], a[24:27], v[216:219], v[32:35]
    ds_read_b128 a[12:15], v4 offset:34816
    s_mul_i32 s63, s60, 4096
    s_add_u32 s63, s63, s3
    v_cmp_eq_u32 vcc, -1, v11
    v_mfma_f32_16x16x32_bf16 v[36:39], a[24:27], v[220:223], v[36:39]
    s_add_u32 s63, s63, 106496
    v_mfma_f32_16x16x32_bf16 v[40:43], a[28:31], v[216:219], v[40:43]
    ds_read_b128 a[16:19], v4 offset:35840
    s_nop 0
    s_cbranch_vccnz Lx16
Lx16_b:
    v_mfma_f32_16x16x32_bf16 v[44:47], a[28:31], v[220:223], v[44:47]
    v_swap_b32 v226, v228
    v_mfma_f32_16x16x32_bf16 v[88:91], v[216:219], v[216:219], v[88:91]
    buffer_load_dwordx4 v3, s[36:39], s63 offen offset:0 sc1 lds
    v_swap_b32 v227, v229
    v_mfma_f32_16x16x32_bf16 v[92:95], v[220:223], v[220:223], v[92:95]
    s_nop 0
    v_mfma_f32_16x16x32_bf16 v[80:83], a[0:3], v[224:227], v[80:83]
    ds_read_b128 a[20:23], v4 offset:36864
    v_mfma_f32_16x16x32_bf16 v[84:87], a[0:3], v[228:231], v[84:87]
    s_waitcnt lgkmcnt(2)
    v_mfma_f32_16x16x32_bf16 v[32:35], a[4:7], v[224:227], v[32:35]
    ds_read_b128 a[24:27], v4 offset:37888
    v_mfma_f32_16x16x32_bf16 v[36:39], a[4:7], v[228:231], v[36:39]
    buffer_load_dwordx4 v3, s[36:39], s63 offen offset:1024 sc1 lds
    v_mfma_f32_16x16x32_bf16 v[40:43], a[8:11], v[224:227], v[40:43]
    ds_read_b128 a[28:31], v4 offset:38912
    v_mfma_f32_16x16x32_bf16 v[44:47], a[8:11], v[228:231], v[44:47]
    v_swap_b32 v234, v236
    v_mfma_f32_16x16x32_bf16 v[88:91], v[224:227], v[224:227], v[88:91]
    v_swap_b32 v235, v237
    v_mfma_f32_16x16x32_bf16 v[92:95], v[228:231], v[228:231], v[92:95]
    s_waitcnt vmcnt(8)
    v_max3_u32 v11, v240, v244, v248
    v_mfma_f32_16x16x32_bf16 v[80:83], a[12:15], v[232:235], v[80:83]
    ds_read_b128 a[0:3], v4 offset:39936
    s_waitcnt vmcnt(7)
    v_max_u32 v11, v11, v252
    v_mfma_f32_16x16x32_bf16 v[84:87], a[12:15], v[236:239], v[84:87]
    buffer_load_dwordx4 v3, s[36:39], s63 offen offset:2048 sc1 lds
    s_waitcnt lgkmcnt(2)
    v_cmp_eq_u32 vcc, -1, v11
    v_mfma_f32_16x16x32_bf16 v[32:35], a[16:19], v[232:235], v[32:35]
    ds_read_b128 a[4:7], v4 offset:40960
    v_mfma_f32_16x16x32_bf16 v[36:39], a[16:19], v[236:239], v[36:39]
    v_mfma_f32_16x16x32_bf16 v[40:43], a[20:23], v[232:235], v[40:43]
    ds_read_b128 a[8:11], v4 offset:41984
    s_cbranch_vccnz Lx18
Lx18_b:
    v_mfma_f32_16x16x32_bf16 v[44:47], a[20:23], v[236:239], v[44:47]
    buffer_load_dwordx4 v3, s[36:39], s63 offen offset:3072 sc1 lds
    s_mul_i32 s63, s60, 33792
    s_add_u32 m0, s63, 4096
    v_mfma_f32_16x16x32_bf16 v[88:91], v[232:235], v[232:235], v[88:91]
    s_mul_i32 s63, s60, 5120
    s_add_u32 s63, s63, s3
    s_add_u32 s63, s63, 122880
    v_swap_b32 v242, v244
    v_swap_b32 v243, v245
    v_mfma_f32_16x16x32_bf16 v[92:95], v[236:239], v[236:239], v[92:95]
    s_nop 0
    v_mfma_f32_16x16x32_bf16 v[80:83], a[24:27], v[240:243], v[80:83]
    ds_read_b128 a[12:15], v4 offset:43008
    v_mfma_f32_16x16x32_bf16 v[84:87], a[24:27], v[244:247], v[84:87]
    s_waitcnt lgkmcnt(2)
    v_mfma_f32_16x16x32_bf16 v[32:35], a[28:31], v[240:243], v[32:35]
    ds_read_b128 a[16:19], v5 offset:0
    v_mfma_f32_16x16x32_bf16 v[36:39], a[28:31], v[244:247], v[36:39]
    buffer_load_dwordx4 v3, s[36:39], s63 offen offset:0 sc1 lds
    v_mfma_f32_16x16x32_bf16 v[40:43], a[0:3], v[240:243], v[40:43]
    ds_read_b128 a[20:23], v5 offset:1024
    v_mfma_f32_16x16x32_bf16 v[44:47], a[0:3], v[244:247], v[44:47]
    v_swap_b32 v250, v252
    v_mfma_f32_16x16x32_bf16 v[88:91], v[240:243], v[240:243], v[88:91]
    v_swap_b32 v251, v253
    v_mfma_f32_16x16x32_bf16 v[92:95], v[244:247], v[244:247], v[92:95]
    buffer_load_dwordx4 v3, s[36:39], s63 offen offset:1024 sc1 lds
    v_mfma_f32_16x16x32_bf16 v[80:83], a[4:7], v[248:251], v[80:83]
    ds_read_b128 a[24:27], v5 offset:2048
    v_mfma_f32_16x16x32_bf16 v[84:87], a[4:7], v[252:255], v[84:87]
    s_waitcnt lgkmcnt(2)
    v_mfma_f32_16x16x32_bf16 v[32:35], a[8:11], v[248:251], v[32:35]
    ds_read_b128 a[28:31], v5 offset:3072
    v_mfma_f32_16x16x32_bf16 v[36:39], a[8:11], v[252:255], v[36:39]
    v_mfma_f32_16x16x32_bf16 v[40:43], a[12:15], v[248:251], v[40:43]
    ds_read_b128 a[0:3], v5 offset:4096
    v_mfma_f32_16x16x32_bf16 v[44:47], a[12:15], v[252:255], v[44:47]
    buffer_load_dwordx4 v3, s[36:39], s63 offen offset:2048 sc1 lds
    v_mfma_f32_16x16x32_bf16 v[88:91], v[248:251], v[248:251], v[88:91]
    v_mfma_f32_16x16x32_bf16 v[92:95], v[252:255], v[252:255], v[92:95]
    v_mfma_f32_16x16x32_bf16 v[48:51], a[16:19], v[96:99], 0
    ds_read_b128 a[4:7], v5 offset:5120
    s_add_u32 s98, s99, 0
    buffer_load_dwordx4 a[32:35], v3, s[36:39], s98 offen offset:0 sc1
    v_mfma_f32_16x16x32_bf16 v[52:55], a[16:19], v[100:103], 0
    buffer_load_dwordx4 v3, s[36:39], s63 offen offset:3072 sc1 lds
    s_waitcnt lgkmcnt(2)
    s_add_u32 m0, m0, 4096
    s_add_u32 s63, s63, 4096
    s_waitcnt vmcnt(11)
    v_mfma_f32_16x16x32_bf16 v[56:59], a[20:23], v[96:99], 0
    ds_read_b128 a[8:11], v5 offset:6144
    ds_bpermute_b32 v14, v9, v80
    v_mfma_f32_16x16x32_bf16 v[60:63], a[20:23], v[100:103], 0
    ds_bpermute_b32 v15, v9, v84
    v_cndmask_b32 v12, v88, v89, s[68:69]
    v_cndmask_b32 v13, v92, v93, s[68:69]
    v_cndmask_b32 v12, v12, v90, s[70:71]
    v_mfma_f32_16x16x32_bf16 v[48:51], a[24:27], v[104:107], v[48:51]
    ds_read_b128 a[12:15], v5 offset:7168
    v_cndmask_b32 v13, v13, v94, s[70:71]
    v_cndmask_b32 v12, v12, v91, s[72:73]
    v_cndmask_b32 v13, v13, v95, s[72:73]
    v_mfma_f32_16x16x32_bf16 v[52:55], a[24:27], v[108:111], v[52:55]
    ds_bpermute_b32 v12, v8, v12
    ds_bpermute_b32 v13, v8, v13
    v_mfma_f32_16x16x32_bf16 v[56:59], a[28:31], v[104:107], v[56:59]
    ds_read_b128 a[16:19], v5 offset:8192
    buffer_load_dwordx4 v3, s[36:39], s63 offen offset:0 sc1 lds
    s_waitcnt lgkmcnt(5)
    v_mul_f32 v14, 0x3acccccd, v14
    v_mfma_f32_16x16x32_bf16 v[60:63], a[28:31], v[108:111], v[60:63]
    buffer_load_dwordx4 a[36:39], v3, s[36:39], s98 offen offset:1024 sc1
    s_waitcnt lgkmcnt(4)
    v_mul_f32 v15, 0x3acccccd, v15
    s_waitcnt lgkmcnt(2)
    v_mul_f32 v12, 0x3acccccd, v12
    v_mfma_f32_16x16x32_bf16 v[48:51], a[0:3], v[112:115], v[48:51]
    ds_read_b128 a[20:23], v5 offset:9216
    s_waitcnt lgkmcnt(2)
    v_mul_f32 v13, 0x3acccccd, v13
    v_fma_f32 v12, -v14, v14, v12
    v_fma_f32 v13, -v15, v15, v13
    v_max_f32 v12, 0, v12
    v_mfma_f32_16x16x32_bf16 v[52:55], a[0:3], v[116:119], v[52:55]
    buffer_load_dwordx4 a[40:43], v3, s[36:39], s98 offen offset:2048 sc1
    v_max_f32 v13, 0, v13
    v_cvt_pk_bf16_f32 v12, v14, v12
    v_cvt_pk_bf16_f32 v13, v15, v13
    v_lshlrev_b32 v14, 16, v12
    v_mfma_f32_16x16x32_bf16 v[56:59], a[4:7], v[112:115], v[56:59]
    ds_read_b128 a[24:27], v5 offset:10240
    v_lshlrev_b32 v15, 16, v13
    v_and_b32 v12, 0xffff0000, v12
    v_and_b32 v13, 0xffff0000, v13
    v_add_f32 v12, 0x3727c5ac, v12
    v_mfma_f32_16x16x32_bf16 v[60:63], a[4:7], v[116:119], v[60:63]
    v_add_f32 v13, 0x3727c5ac, v13
    v_cvt_pk_bf16_f32 v12, v12, v12
    v_cvt_pk_bf16_f32 v13, v13, v13
    v_lshlrev_b32 v12, 16, v12
    v_lshlrev_b32 v13, 16, v13
    v_mfma_f32_16x16x32_bf16 v[48:51], a[8:11], v[120:123], v[48:51]
    ds_read_b128 a[28:31], v5 offset:11264
    v_sqrt_f32 v12, v12
    v_sqrt_f32 v13, v13
    v_mfma_f32_16x16x32_bf16 v[52:55], a[8:11], v[124:127], v[52:55]
    buffer_load_dwordx4 a[44:47], v3, s[36:39], s98 offen offset:3072 sc1
    v_cvt_pk_bf16_f32 v12, v12, v12
    v_cvt_pk_bf16_f32 v13, v13, v13
    v_lshlrev_b32 v12, 16, v12
    v_lshlrev_b32 v13, 16, v13
    v_mfma_f32_16x16x32_bf16 v[56:59], a[12:15], v[120:123], v[56:59]
    ds_read_b128 a[0:3], v5 offset:12288
    v_rcp_f32 v12, v12
    v_rcp_f32 v13, v13
    v_mfma_f32_16x16x32_bf16 v[60:63], a[12:15], v[124:127], v[60:63]
    s_waitcnt lgkmcnt(2)
    v_mul_f32 v12, 0xbfb8aa3b, v12
    v_mul_f32 v13, 0xbfb8aa3b, v13
    v_mul_f32 v14, -v14, v12
    v_mul_f32 v15, -v15, v13
    v_mfma_f32_16x16x32_bf16 v[48:51], a[16:19], v[128:131], v[48:51]
    ds_read_b128 a[4:7], v5 offset:13312
    s_add_u32 s98, s98, 4096
    ds_read_b128 v[16:19], v10 offset:384
    ds_read_b128 v[20:23], v10 offset:832
    v_mfma_f32_16x16x32_bf16 v[52:55], a[16:19], v[132:135], v[52:55]
    buffer_load_dwordx4 a[48:51], v3, s[36:39], s98 offen offset:0 sc1
    s_waitcnt lgkmcnt(0)
    v_fma_f32 v24, v16, v14, v20
    v_fma_f32 v25, v17, v14, v21
    v_fma_f32 v26, v18, v14, v22
    v_fma_f32 v27, v19, v14, v23
    v_mfma_f32_16x16x32_bf16 v[56:59], a[20:23], v[128:131], v[56:59]
    ds_read_b128 a[8:11], v5 offset:14336
    v_fmac_f32 v24, v80, v12
    v_fmac_f32 v25, v81, v12
    v_fmac_f32 v26, v82, v12
    v_fmac_f32 v27, v83, v12
    v_mfma_f32_16x16x32_bf16 v[60:63], a[20:23], v[132:135], v[60:63]
    v_exp_f32 v80, v24
    v_exp_f32 v81, v25
    v_mfma_f32_16x16x32_bf16 v[48:51], a[24:27], v[136:139], v[48:51]
    ds_read_b128 a[12:15], v5 offset:15360
    s_add_u32 s98, s99, 5120
    v_exp_f32 v82, v26
    v_exp_f32 v83, v27
    v_mfma_f32_16x16x32_bf16 v[52:55], a[24:27], v[140:143], v[52:55]
    buffer_load_dwordx4 a[52:55], v3, s[36:39], s98 offen offset:0 sc1
    v_add_f32 v80, 1.0, v80
    v_add_f32 v81, 1.0, v81
    v_add_f32 v82, 1.0, v82
    v_add_f32 v83, 1.0, v83
    v_mfma_f32_16x16x32_bf16 v[56:59], a[28:31], v[136:139], v[56:59]
    ds_read_b128 a[16:19], v5 offset:16384
    v_rcp_f32 v80, v80
    v_rcp_f32 v81, v81
    v_mfma_f32_16x16x32_bf16 v[60:63], a[28:31], v[140:143], v[60:63]
    v_rcp_f32 v82, v82
    v_rcp_f32 v83, v83
    v_mul_f32 v80, v80, v24
    v_mfma_f32_16x16x32_bf16 v[48:51], a[0:3], v[144:147], v[48:51]
    ds_read_b128 a[20:23], v5 offset:17408
    v_mul_f32 v81, v81, v25
    v_mul_f32 v82, v82, v26
    v_mul_f32 v83, v83, v27
    v_cvt_pk_bf16_f32 v80, v80, v81
    v_mfma_f32_16x16x32_bf16 v[52:55], a[0:3], v[148:151], v[52:55]
    buffer_load_dwordx4 a[56:59], v3, s[36:39], s98 offen offset:1024 sc1
    v_cvt_pk_bf16_f32 v81, v82, v83
    v_mfma_f32_16x16x32_bf16 v[56:59], a[4:7], v[144:147], v[56:59]
    ds_read_b128 a[24:27], v5 offset:18432
    buffer_store_dwordx2 v[80:81], v3, s[36:39], s76 offen sc1
    v_mfma_f32_16x16x32_bf16 v[60:63], a[4:7], v[148:151], v[60:63]
    s_waitcnt lgkmcnt(2)
    v_fmac_f32 v20, v16, v15
    v_fmac_f32 v21, v17, v15
    v_fmac_f32 v22, v18, v15
    v_fmac_f32 v23, v19, v15
    v_fmac_f32 v20, v84, v13
    v_mfma_f32_16x16x32_bf16 v[48:51], a[8:11], v[152:155], v[48:51]
    ds_read_b128 a[28:31], v5 offset:19456
    v_fmac_f32 v21, v85, v13
    v_fmac_f32 v22, v86, v13
    v_fmac_f32 v23, v87, v13
    v_mfma_f32_16x16x32_bf16 v[52:55], a[8:11], v[156:159], v[52:55]
    buffer_load_dwordx4 a[60:63], v3, s[36:39], s98 offen offset:2048 sc1
    v_exp_f32 v84, v20
    v_exp_f32 v85, v21
    v_mfma_f32_16x16x32_bf16 v[56:59], a[12:15], v[152:155], v[56:59]
    ds_read_b128 a[0:3], v5 offset:20480
    v_exp_f32 v86, v22
    v_exp_f32 v87, v23
    v_mfma_f32_16x16x32_bf16 v[60:63], a[12:15], v[156:159], v[60:63]
    v_add_f32 v84, 1.0, v84
    v_add_f32 v85, 1.0, v85
    v_add_f32 v86, 1.0, v86
    v_add_f32 v87, 1.0, v87
    v_mfma_f32_16x16x32_bf16 v[48:51], a[16:19], v[160:163], v[48:51]
    ds_read_b128 a[4:7], v5 offset:21504
    v_rcp_f32 v84, v84
    v_rcp_f32 v85, v85
    v_mfma_f32_16x16x32_bf16 v[52:55], a[16:19], v[164:167], v[52:55]
    buffer_load_dwordx4 a[64:67], v3, s[36:39], s98 offen offset:3072 sc1
    s_waitcnt lgkmcnt(2)
    v_rcp_f32 v86, v86
    v_rcp_f32 v87, v87
    v_mfma_f32_16x16x32_bf16 v[56:59], a[20:23], v[160:163], v[56:59]
    ds_read_b128 a[8:11], v5 offset:22528
    v_mul_f32 v84, v84, v20
    v_mul_f32 v85, v85, v21
    v_mul_f32 v86, v86, v22
    v_mul_f32 v87, v87, v23
    v_mfma_f32_16x16x32_bf16 v[60:63], a[20:23], v[164:167], v[60:63]
    v_cvt_pk_bf16_f32 v84, v84, v85
    v_cvt_pk_bf16_f32 v85, v86, v87
    v_mfma_f32_16x16x32_bf16 v[48:51], a[24:27], v[168:171], v[48:51]
    ds_read_b128 a[12:15], v5 offset:23552
    s_add_u32 s98, s98, 4096
    buffer_store_dwordx2 v[84:85], v3, s[36:39], s77 offen sc1
    v_mfma_f32_16x16x32_bf16 v[52:55], a[24:27], v[172:175], v[52:55]
    ds_read_b128 v[88:91], v10 offset:0
    ds_read_b128 v[92:95], v10 offset:448
    s_waitcnt lgkmcnt(0)
    v_fma_f32 v24, v88, v14, v92
    v_fma_f32 v25, v89, v14, v93
    v_mfma_f32_16x16x32_bf16 v[56:59], a[28:31], v[168:171], v[56:59]
    ds_read_b128 a[16:19], v5 offset:24576
    v_fma_f32 v26, v90, v14, v94
    v_fma_f32 v27, v91, v14, v95
    v_fmac_f32 v24, v32, v12
    v_fmac_f32 v25, v33, v12
    v_mfma_f32_16x16x32_bf16 v[60:63], a[28:31], v[172:175], v[60:63]
    buffer_load_dwordx4 a[68:71], v3, s[36:39], s98 offen offset:0 sc1
    v_fmac_f32 v26, v34, v12
    v_fmac_f32 v27, v35, v12
    v_exp_f32 v32, v24
    v_mfma_f32_16x16x32_bf16 v[48:51], a[0:3], v[176:179], v[48:51]
    ds_read_b128 a[20:23], v5 offset:25600
    s_add_u32 s98, s99, 10240
    v_exp_f32 v33, v25
    v_exp_f32 v34, v26
    v_mfma_f32_16x16x32_bf16 v[52:55], a[0:3], v[180:183], v[52:55]
    buffer_load_dwordx4 a[72:75], v3, s[36:39], s98 offen offset:0 sc1
    v_exp_f32 v35, v27
    v_add_f32 v32, 1.0, v32
    v_add_f32 v33, 1.0, v33
    v_mfma_f32_16x16x32_bf16 v[56:59], a[4:7], v[176:179], v[56:59]
    ds_read_b128 a[24:27], v5 offset:26624
    v_add_f32 v34, 1.0, v34
    v_add_f32 v35, 1.0, v35
    v_rcp_f32 v32, v32
    v_mfma_f32_16x16x32_bf16 v[60:63], a[4:7], v[180:183], v[60:63]
    v_rcp_f32 v33, v33
    v_rcp_f32 v34, v34
    v_mfma_f32_16x16x32_bf16 v[48:51], a[8:11], v[184:187], v[48:51]
    ds_read_b128 a[28:31], v5 offset:27648
    v_rcp_f32 v35, v35
    v_mul_f32 v32, v32, v24
    v_mul_f32 v33, v33, v25
    v_mfma_f32_16x16x32_bf16 v[52:55], a[8:11], v[188:191], v[52:55]
    buffer_load_dwordx4 a[76:79], v3, s[36:39], s98 offen offset:1024 sc1
    s_waitcnt vmcnt(13)
    s_barrier
    v_mul_f32 v34, v34, v26
    v_mul_f32 v35, v35, v27
    v_cvt_pk_bf16_f32 v32, v32, v33
    v_mfma_f32_16x16x32_bf16 v[56:59], a[12:15], v[184:187], v[56:59]
    ds_read_b128 a[0:3], v3 offset:0
    v_cvt_pk_bf16_f32 v33, v34, v35
    v_fmac_f32 v92, v88, v15
    v_fmac_f32 v93, v89, v15
    v_fmac_f32 v94, v90, v15
    v_mfma_f32_16x16x32_bf16 v[60:63], a[12:15], v[188:191], v[60:63]
    s_waitcnt lgkmcnt(2)
    v_fmac_f32 v95, v91, v15
    v_fmac_f32 v92, v36, v13
    v_fmac_f32 v93, v37, v13
    v_fmac_f32 v94, v38, v13
    v_fmac_f32 v95, v39, v13
    v_mfma_f32_16x16x32_bf16 v[48:51], a[16:19], v[192:195], v[48:51]
    ds_read_b128 a[4:7], v3 offset:1024
    v_exp_f32 v36, v92
    v_exp_f32 v37, v93
    v_mfma_f32_16x16x32_bf16 v[52:55], a[16:19], v[196:199], v[52:55]
    buffer_load_dwordx4 a[80:83], v3, s[36:39], s98 offen offset:2048 sc1
    v_exp_f32 v38, v94
    v_exp_f32 v39, v95
    v_mfma_f32_16x16x32_bf16 v[56:59], a[20:23], v[192:195], v[56:59]
    ds_read_b128 a[8:11], v3 offset:2048
    v_add_f32 v36, 1.0, v36
    v_add_f32 v37, 1.0, v37
    v_add_f32 v38, 1.0, v38
    v_add_f32 v39, 1.0, v39
    v_mfma_f32_16x16x32_bf16 v[60:63], a[20:23], v[196:199], v[60:63]
    v_rcp_f32 v36, v36
    v_rcp_f32 v37, v37
    v_mfma_f32_16x16x32_bf16 v[48:51], a[24:27], v[200:203], v[48:51]
    ds_read_b128 a[12:15], v3 offset:3072
    v_rcp_f32 v38, v38
    v_rcp_f32 v39, v39
    v_mfma_f32_16x16x32_bf16 v[52:55], a[24:27], v[204:207], v[52:55]
    buffer_load_dwordx4 a[84:87], v3, s[36:39], s98 offen offset:3072 sc1
    s_waitcnt lgkmcnt(2)
    v_mul_f32 v36, v36, v92
    v_mul_f32 v37, v37, v93
    v_mul_f32 v38, v38, v94
    v_mul_f32 v39, v39, v95
    v_mfma_f32_16x16x32_bf16 v[56:59], a[28:31], v[200:203], v[56:59]
    ds_read_b128 a[16:19], v3 offset:33792
    v_cvt_pk_bf16_f32 v36, v36, v37
    v_cvt_pk_bf16_f32 v37, v38, v39
    v_mfma_f32_16x16x32_bf16 v[60:63], a[28:31], v[204:207], v[60:63]
    ds_read_b128 v[16:19], v10 offset:64
    ds_read_b128 v[20:23], v10 offset:512
    s_waitcnt lgkmcnt(0)
    v_fma_f32 v24, v16, v14, v20
    v_fma_f32 v25, v17, v14, v21
    v_mfma_f32_16x16x32_bf16 v[48:51], a[0:3], v[208:211], v[48:51]
    ds_read_b128 a[20:23], v3 offset:34816
    s_add_u32 s98, s98, 4096
    v_fma_f32 v26, v18, v14, v22
    v_fma_f32 v27, v19, v14, v23
    v_fmac_f32 v24, v40, v12
    v_fmac_f32 v25, v41, v12
    v_mfma_f32_16x16x32_bf16 v[52:55], a[0:3], v[212:215], v[52:55]
    buffer_load_dwordx4 a[88:91], v3, s[36:39], s98 offen offset:0 sc1
    v_fmac_f32 v26, v42, v12
    v_fmac_f32 v27, v43, v12
    v_exp_f32 v40, v24
    v_mfma_f32_16x16x32_bf16 v[56:59], a[4:7], v[208:211], v[56:59]
    ds_read_b128 a[24:27], v3 offset:35840
    v_exp_f32 v41, v25
    v_exp_f32 v42, v26
    v_mfma_f32_16x16x32_bf16 v[60:63], a[4:7], v[212:215], v[60:63]
    v_exp_f32 v43, v27
    v_add_f32 v40, 1.0, v40
    v_add_f32 v41, 1.0, v41
    v_add_f32 v42, 1.0, v42
    v_mfma_f32_16x16x32_bf16 v[48:51], a[8:11], v[216:219], v[48:51]
    ds_read_b128 a[28:31], v3 offset:36864
    s_add_u32 s98, s99, 15360
    v_add_f32 v43, 1.0, v43
    v_rcp_f32 v40, v40
    v_mfma_f32_16x16x32_bf16 v[52:55], a[8:11], v[220:223], v[52:55]
    buffer_load_dwordx4 a[92:95], v3, s[36:39], s98 offen offset:0 sc1
    v_rcp_f32 v41, v41
    v_rcp_f32 v42, v42
    v_mfma_f32_16x16x32_bf16 v[56:59], a[12:15], v[216:219], v[56:59]
    ds_read_b128 a[0:3], v4 offset:10240
    v_rcp_f32 v43, v43
    v_mul_f32 v40, v40, v24
    v_mul_f32 v41, v41, v25
    v_mfma_f32_16x16x32_bf16 v[60:63], a[12:15], v[220:223], v[60:63]
    v_mul_f32 v42, v42, v26
    v_mul_f32 v43, v43, v27
    v_cvt_pk_bf16_f32 v34, v40, v41
    v_cvt_pk_bf16_f32 v35, v42, v43
    v_mfma_f32_16x16x32_bf16 v[48:51], a[16:19], v[224:227], v[48:51]
    ds_read_b128 a[4:7], v4 offset:11264
    buffer_load_dwordx4 a[96:99], v3, s[36:39], s98 offen offset:1024 sc1
    v_mfma_f32_16x16x32_bf16 v[52:55], a[16:19], v[228:231], v[52:55]
    buffer_store_dwordx4 v[32:35], v3, s[36:39], s74 offen offset:0 sc1
    s_waitcnt lgkmcnt(2)
    v_mfma_f32_16x16x32_bf16 v[56:59], a[20:23], v[224:227], v[56:59]
    ds_read_b128 a[8:11], v4 offset:12288
    v_fmac_f32 v20, v16, v15
    v_fmac_f32 v21, v17, v15
    v_fmac_f32 v22, v18, v15
    v_fmac_f32 v23, v19, v15
    v_mfma_f32_16x16x32_bf16 v[60:63], a[20:23], v[228:231], v[60:63]
    v_fmac_f32 v20, v44, v13
    v_fmac_f32 v21, v45, v13
    v_fmac_f32 v22, v46, v13
    v_fmac_f32 v23, v47, v13
    v_mfma_f32_16x16x32_bf16 v[48:51], a[24:27], v[232:235], v[48:51]
    ds_read_b128 a[12:15], v4 offset:13312
    v_exp_f32 v44, v20
    v_exp_f32 v45, v21
    v_mfma_f32_16x16x32_bf16 v[52:55], a[24:27], v[236:239], v[52:55]
    buffer_load_dwordx4 a[100:103], v3, s[36:39], s98 offen offset:2048 sc1
    v_exp_f32 v46, v22
    v_exp_f32 v47, v23
    v_mfma_f32_16x16x32_bf16 v[56:59], a[28:31], v[232:235], v[56:59]
    ds_read_b128 a[16:19], v4 offset:44032
    v_add_f32 v44, 1.0, v44
    v_add_f32 v45, 1.0, v45
    v_add_f32 v46, 1.0, v46
    v_add_f32 v47, 1.0, v47
    v_mfma_f32_16x16x32_bf16 v[60:63], a[28:31], v[236:239], v[60:63]
    s_waitcnt lgkmcnt(2)
    v_rcp_f32 v44, v44
    v_rcp_f32 v45, v45
    v_mfma_f32_16x16x32_bf16 v[48:51], a[0:3], v[240:243], v[48:51]
    ds_read_b128 a[20:23], v4 offset:45056
    v_rcp_f32 v46, v46
    v_rcp_f32 v47, v47
    v_mfma_f32_16x16x32_bf16 v[52:55], a[0:3], v[244:247], v[52:55]
    buffer_load_dwordx4 a[104:107], v3, s[36:39], s98 offen offset:3072 sc1
    v_mul_f32 v44, v44, v20
    v_mul_f32 v45, v45, v21
    v_mul_f32 v46, v46, v22
    v_mul_f32 v47, v47, v23
    v_mfma_f32_16x16x32_bf16 v[56:59], a[4:7], v[240:243], v[56:59]
    ds_read_b128 a[24:27], v4 offset:46080
    v_cvt_pk_bf16_f32 v38, v44, v45
    v_cvt_pk_bf16_f32 v39, v46, v47
    v_mfma_f32_16x16x32_bf16 v[60:63], a[4:7], v[244:247], v[60:63]
    buffer_store_dwordx4 v[36:39], v3, s[36:39], s75 offen offset:0 sc1
    v_mfma_f32_16x16x32_bf16 v[48:51], a[8:11], v[248:251], v[48:51]
    ds_read_b128 a[28:31], v4 offset:47104
    s_add_u32 s98, s98, 4096
    buffer_load_dwordx4 a[108:111], v3, s[36:39], s98 offen offset:0 sc1
    v_mfma_f32_16x16x32_bf16 v[52:55], a[8:11], v[252:255], v[52:55]
    s_waitcnt lgkmcnt(2)
    v_mfma_f32_16x16x32_bf16 v[56:59], a[12:15], v[248:251], v[56:59]
    ds_read_b128 a[0:3], v3 offset:9216
    v_mfma_f32_16x16x32_bf16 v[60:63], a[12:15], v[252:255], v[60:63]
    v_mfma_f32_16x16x32_bf16 v[64:67], a[16:19], v[96:99], 0
    ds_read_b128 a[4:7], v3 offset:10240
    s_add_u32 s98, s99, 20480
    buffer_load_dwordx4 a[112:115], v3, s[36:39], s98 offen offset:0 sc1
    v_mfma_f32_16x16x32_bf16 v[68:71], a[16:19], v[100:103], 0
    ds_read_b128 v[88:91], v10 offset:128
    ds_read_b128 v[92:95], v10 offset:576
    s_waitcnt lgkmcnt(0)
    v_fma_f32 v24, v88, v14, v92
    v_fma_f32 v25, v89, v14, v93
    v_mfma_f32_16x16x32_bf16 v[72:75], a[20:23], v[96:99], 0
    ds_read_b128 a[8:11], v3 offset:11264
    v_fma_f32 v26, v90, v14, v94
    v_fma_f32 v27, v91, v14, v95
    v_fmac_f32 v24, v48, v12
    v_fmac_f32 v25, v49, v12
    v_mfma_f32_16x16x32_bf16 v[76:79], a[20:23], v[100:103], 0
    v_fmac_f32 v26, v50, v12
    v_fmac_f32 v27, v51, v12
    v_exp_f32 v48, v24
    v_mfma_f32_16x16x32_bf16 v[64:67], a[24:27], v[104:107], v[64:67]
    ds_read_b128 a[12:15], v3 offset:12288
    v_exp_f32 v49, v25
    v_exp_f32 v50, v26
    v_mfma_f32_16x16x32_bf16 v[68:71], a[24:27], v[108:111], v[68:71]
    buffer_load_dwordx4 a[116:119], v3, s[36:39], s98 offen offset:1024 sc1
    v_exp_f32 v51, v27
    v_add_f32 v48, 1.0, v48
    v_add_f32 v49, 1.0, v49
    v_mfma_f32_16x16x32_bf16 v[72:75], a[28:31], v[104:107], v[72:75]
    ds_read_b128 a[16:19], v3 offset:43008
    v_add_f32 v50, 1.0, v50
    v_add_f32 v51, 1.0, v51
    v_rcp_f32 v48, v48
    v_mfma_f32_16x16x32_bf16 v[76:79], a[28:31], v[108:111], v[76:79]
    v_rcp_f32 v49, v49
    v_rcp_f32 v50, v50
    v_mfma_f32_16x16x32_bf16 v[64:67], a[0:3], v[112:115], v[64:67]
    ds_read_b128 a[20:23], v3 offset:44032
    v_rcp_f32 v51, v51
    v_mul_f32 v48, v48, v24
    v_mul_f32 v49, v49, v25
    v_mfma_f32_16x16x32_bf16 v[68:71], a[0:3], v[116:119], v[68:71]
    buffer_load_dwordx4 a[120:123], v3, s[36:39], s98 offen offset:2048 sc1
    v_mul_f32 v50, v50, v26
    v_mul_f32 v51, v51, v27
    v_cvt_pk_bf16_f32 v48, v48, v49
    v_cvt_pk_bf16_f32 v49, v50, v51
    v_mfma_f32_16x16x32_bf16 v[72:75], a[4:7], v[112:115], v[72:75]
    ds_read_b128 a[24:27], v3 offset:45056
    v_fmac_f32 v92, v88, v15
    v_fmac_f32 v93, v89, v15
    v_fmac_f32 v94, v90, v15
    v_fmac_f32 v95, v91, v15
    v_mfma_f32_16x16x32_bf16 v[76:79], a[4:7], v[116:119], v[76:79]
    s_waitcnt lgkmcnt(2)
    v_fmac_f32 v92, v52, v13
    v_fmac_f32 v93, v53, v13
    v_fmac_f32 v94, v54, v13
    v_fmac_f32 v95, v55, v13
    v_mfma_f32_16x16x32_bf16 v[64:67], a[8:11], v[120:123], v[64:67]
    ds_read_b128 a[28:31], v3 offset:46080
    v_exp_f32 v52, v92
    v_exp_f32 v53, v93
    v_mfma_f32_16x16x32_bf16 v[68:71], a[8:11], v[124:127], v[68:71]
    buffer_load_dwordx4 a[124:127], v3, s[36:39], s98 offen offset:3072 sc1
    v_exp_f32 v54, v94
    v_exp_f32 v55, v95
    v_mfma_f32_16x16x32_bf16 v[72:75], a[12:15], v[120:123], v[72:75]
    ds_read_b128 a[0:3], v4 offset:19456
    v_add_f32 v52, 1.0, v52
    v_add_f32 v53, 1.0, v53
    v_add_f32 v54, 1.0, v54
    v_add_f32 v55, 1.0, v55
    v_mfma_f32_16x16x32_bf16 v[76:79], a[12:15], v[124:127], v[76:79]
    v_rcp_f32 v52, v52
    v_rcp_f32 v53, v53
    v_mfma_f32_16x16x32_bf16 v[64:67], a[16:19], v[128:131], v[64:67]
    ds_read_b128 a[4:7], v4 offset:20480
    s_add_u32 s98, s98, 4096
    v_rcp_f32 v54, v54
    v_rcp_f32 v55, v55
    v_mfma_f32_16x16x32_bf16 v[68:71], a[16:19], v[132:135], v[68:71]
    buffer_load_dwordx4 a[128:131], v3, s[36:39], s98 offen offset:0 sc1
    s_waitcnt lgkmcnt(2)
    v_mul_f32 v52, v52, v92
    v_mul_f32 v53, v53, v93
    v_mul_f32 v54, v54, v94
    v_mul_f32 v55, v55, v95
    v_mfma_f32_16x16x32_bf16 v[72:75], a[20:23], v[128:131], v[72:75]
    ds_read_b128 a[8:11], v4 offset:21504
    v_cvt_pk_bf16_f32 v52, v52, v53
    v_cvt_pk_bf16_f32 v53, v54, v55
    v_mfma_f32_16x16x32_bf16 v[76:79], a[20:23], v[132:135], v[76:79]
    ds_read_b128 v[16:19], v10 offset:192
    ds_read_b128 v[20:23], v10 offset:640
    s_waitcnt lgkmcnt(0)
    v_fma_f32 v24, v16, v14, v20
    v_fma_f32 v25, v17, v14, v21
    v_mfma_f32_16x16x32_bf16 v[64:67], a[24:27], v[136:139], v[64:67]
    ds_read_b128 a[12:15], v4 offset:22528
    s_add_u32 s98, s99, 25600
    v_fma_f32 v26, v18, v14, v22
    v_fma_f32 v27, v19, v14, v23
    v_fmac_f32 v24, v56, v12
    v_fmac_f32 v25, v57, v12
    v_mfma_f32_16x16x32_bf16 v[68:71], a[24:27], v[140:143], v[68:71]
    buffer_load_dwordx4 a[132:135], v3, s[36:39], s98 offen offset:0 sc1
    v_fmac_f32 v26, v58, v12
    v_fmac_f32 v27, v59, v12
    v_exp_f32 v56, v24
    v_mfma_f32_16x16x32_bf16 v[72:75], a[28:31], v[136:139], v[72:75]
    ds_read_b128 a[16:19], v4 offset:53248
    v_exp_f32 v57, v25
    v_exp_f32 v58, v26
    v_mfma_f32_16x16x32_bf16 v[76:79], a[28:31], v[140:143], v[76:79]
    v_exp_f32 v59, v27
    v_add_f32 v56, 1.0, v56
    v_add_f32 v57, 1.0, v57
    v_add_f32 v58, 1.0, v58
    v_mfma_f32_16x16x32_bf16 v[64:67], a[0:3], v[144:147], v[64:67]
    ds_read_b128 a[20:23], v4 offset:54272
    v_add_f32 v59, 1.0, v59
    v_rcp_f32 v56, v56
    v_mfma_f32_16x16x32_bf16 v[68:71], a[0:3], v[148:151], v[68:71]
    buffer_load_dwordx4 a[136:139], v3, s[36:39], s98 offen offset:1024 sc1
    v_rcp_f32 v57, v57
    v_rcp_f32 v58, v58
    v_mfma_f32_16x16x32_bf16 v[72:75], a[4:7], v[144:147], v[72:75]
    ds_read_b128 a[24:27], v4 offset:55296
    v_rcp_f32 v59, v59
    v_mul_f32 v56, v56, v24
    v_mul_f32 v57, v57, v25
    v_mfma_f32_16x16x32_bf16 v[76:79], a[4:7], v[148:151], v[76:79]
    v_mul_f32 v58, v58, v26
    v_mul_f32 v59, v59, v27
    v_cvt_pk_bf16_f32 v50, v56, v57
    v_cvt_pk_bf16_f32 v51, v58, v59
    v_mfma_f32_16x16x32_bf16 v[64:67], a[8:11], v[152:155], v[64:67]
    ds_read_b128 a[28:31], v4 offset:56320
    buffer_load_dwordx4 a[140:143], v3, s[36:39], s98 offen offset:2048 sc1
    v_mfma_f32_16x16x32_bf16 v[68:71], a[8:11], v[156:159], v[68:71]
    buffer_store_dwordx4 v[48:51], v3, s[36:39], s74 offen offset:1024 sc1
    s_waitcnt lgkmcnt(2)
    v_mfma_f32_16x16x32_bf16 v[72:75], a[12:15], v[152:155], v[72:75]
    ds_read_b128 a[0:3], v3 offset:4096
    v_fmac_f32 v20, v16, v15
    v_fmac_f32 v21, v17, v15
    v_fmac_f32 v22, v18, v15
    v_fmac_f32 v23, v19, v15
    v_mfma_f32_16x16x32_bf16 v[76:79], a[12:15], v[156:159], v[76:79]
    v_fmac_f32 v20, v60, v13
    v_fmac_f32 v21, v61, v13
    v_fmac_f32 v22, v62, v13
    v_fmac_f32 v23, v63, v13
    v_mfma_f32_16x16x32_bf16 v[64:67], a[16:19], v[160:163], v[64:67]
    ds_read_b128 a[4:7], v3 offset:5120
    v_exp_f32 v60, v20
    v_exp_f32 v61, v21
    v_mfma_f32_16x16x32_bf16 v[68:71], a[16:19], v[164:167], v[68:71]
    buffer_load_dwordx4 a[144:147], v3, s[36:39], s98 offen offset:3072 sc1
    v_exp_f32 v62, v22
    v_exp_f32 v63, v23
    v_mfma_f32_16x16x32_bf16 v[72:75], a[20:23], v[160:163], v[72:75]
    ds_read_b128 a[8:11], v3 offset:6144
    v_add_f32 v60, 1.0, v60
    v_add_f32 v61, 1.0, v61
    v_add_f32 v62, 1.0, v62
    v_add_f32 v63, 1.0, v63
    v_mfma_f32_16x16x32_bf16 v[76:79], a[20:23], v[164:167], v[76:79]
    s_waitcnt lgkmcnt(2)
    v_rcp_f32 v60, v60
    v_rcp_f32 v61, v61
    v_mfma_f32_16x16x32_bf16 v[64:67], a[24:27], v[168:171], v[64:67]
    ds_read_b128 a[12:15], v3 offset:7168
    s_add_u32 s98, s98, 4096
    v_rcp_f32 v62, v62
    v_rcp_f32 v63, v63
    v_mfma_f32_16x16x32_bf16 v[68:71], a[24:27], v[172:175], v[68:71]
    buffer_load_dwordx4 a[148:151], v3, s[36:39], s98 offen offset:0 sc1
    v_mul_f32 v60, v60, v20
    v_mul_f32 v61, v61, v21
    v_mul_f32 v62, v62, v22
    v_mul_f32 v63, v63, v23
    v_mfma_f32_16x16x32_bf16 v[72:75], a[28:31], v[168:171], v[72:75]
    ds_read_b128 a[16:19], v3 offset:8192
    v_cvt_pk_bf16_f32 v54, v60, v61
    v_cvt_pk_bf16_f32 v55, v62, v63
    v_mfma_f32_16x16x32_bf16 v[76:79], a[28:31], v[172:175], v[76:79]
    buffer_store_dwordx4 v[52:55], v3, s[36:39], s75 offen offset:1024 sc1
    v_mfma_f32_16x16x32_bf16 v[64:67], a[0:3], v[176:179], v[64:67]
    ds_read_b128 a[20:23], v3 offset:37888
    s_add_u32 s98, s99, 30720
    buffer_load_dwordx4 a[152:155], v3, s[36:39], s98 offen offset:0 sc1
    v_mfma_f32_16x16x32_bf16 v[68:71], a[0:3], v[180:183], v[68:71]
    s_waitcnt lgkmcnt(2)
    v_mfma_f32_16x16x32_bf16 v[72:75], a[4:7], v[176:179], v[72:75]
    ds_read_b128 a[24:27], v3 offset:38912
    v_mfma_f32_16x16x32_bf16 v[76:79], a[4:7], v[180:183], v[76:79]
    v_mfma_f32_16x16x32_bf16 v[64:67], a[8:11], v[184:187], v[64:67]
    ds_read_b128 a[28:31], v3 offset:39936
    buffer_load_dwordx4 a[156:159], v3, s[36:39], s98 offen offset:1024 sc1
    v_mfma_f32_16x16x32_bf16 v[68:71], a[8:11], v[188:191], v[68:71]
    v_mfma_f32_16x16x32_bf16 v[72:75], a[12:15], v[184:187], v[72:75]
    ds_read_b128 a[0:3], v3 offset:40960
    v_mfma_f32_16x16x32_bf16 v[76:79], a[12:15], v[188:191], v[76:79]
    s_waitcnt lgkmcnt(3)
    v_mfma_f32_16x16x32_bf16 v[64:67], a[16:19], v[192:195], v[64:67]
    ds_read_b128 a[4:7], v3 offset:41984
    buffer_load_dwordx4 a[160:163], v3, s[36:39], s98 offen offset:2048 sc1
    v_mfma_f32_16x16x32_bf16 v[68:71], a[16:19], v[196:199], v[68:71]
    v_mfma_f32_16x16x32_bf16 v[72:75], a[20:23], v[192:195], v[72:75]
    ds_read_b128 a[8:11], v4 offset:14336
    v_mfma_f32_16x16x32_bf16 v[76:79], a[20:23], v[196:199], v[76:79]
    s_waitcnt lgkmcnt(3)
    v_mfma_f32_16x16x32_bf16 v[64:67], a[24:27], v[200:203], v[64:67]
    ds_read_b128 a[12:15], v4 offset:15360
    buffer_load_dwordx4 a[164:167], v3, s[36:39], s98 offen offset:3072 sc1
    v_mfma_f32_16x16x32_bf16 v[68:71], a[24:27], v[204:207], v[68:71]
    v_mfma_f32_16x16x32_bf16 v[72:75], a[28:31], v[200:203], v[72:75]
    ds_read_b128 a[16:19], v4 offset:16384
    v_mfma_f32_16x16x32_bf16 v[76:79], a[28:31], v[204:207], v[76:79]
    s_waitcnt lgkmcnt(3)
    v_mfma_f32_16x16x32_bf16 v[64:67], a[0:3], v[208:211], v[64:67]
    ds_read_b128 a[20:23], v4 offset:17408
    s_add_u32 s98, s98, 4096
    buffer_load_dwordx4 a[168:171], v3, s[36:39], s98 offen offset:0 sc1
    v_mfma_f32_16x16x32_bf16 v[68:71], a[0:3], v[212:215], v[68:71]
    v_mfma_f32_16x16x32_bf16 v[72:75], a[4:7], v[208:211], v[72:75]
    ds_read_b128 a[24:27], v4 offset:18432
    v_mfma_f32_16x16x32_bf16 v[76:79], a[4:7], v[212:215], v[76:79]
    s_waitcnt lgkmcnt(3)
    v_mfma_f32_16x16x32_bf16 v[64:67], a[8:11], v[216:219], v[64:67]
    ds_read_b128 a[28:31], v4 offset:48128
    s_add_u32 s98, s99, 35840
    buffer_load_dwordx4 a[172:175], v3, s[36:39], s98 offen offset:0 sc1
    v_mfma_f32_16x16x32_bf16 v[68:71], a[8:11], v[220:223], v[68:71]
    v_mfma_f32_16x16x32_bf16 v[72:75], a[12:15], v[216:219], v[72:75]
    ds_read_b128 a[0:3], v4 offset:49152
    v_mfma_f32_16x16x32_bf16 v[76:79], a[12:15], v[220:223], v[76:79]
    s_waitcnt lgkmcnt(3)
    v_mfma_f32_16x16x32_bf16 v[64:67], a[16:19], v[224:227], v[64:67]
    ds_read_b128 a[4:7], v4 offset:50176
    buffer_load_dwordx4 a[176:179], v3, s[36:39], s98 offen offset:1024 sc1
    v_mfma_f32_16x16x32_bf16 v[68:71], a[16:19], v[228:231], v[68:71]
    v_mfma_f32_16x16x32_bf16 v[72:75], a[20:23], v[224:227], v[72:75]
    ds_read_b128 a[8:11], v4 offset:51200
    v_mfma_f32_16x16x32_bf16 v[76:79], a[20:23], v[228:231], v[76:79]
    s_waitcnt lgkmcnt(3)
    v_mfma_f32_16x16x32_bf16 v[64:67], a[24:27], v[232:235], v[64:67]
    ds_read_b128 a[12:15], v4 offset:52224
    buffer_load_dwordx4 a[180:183], v3, s[36:39], s98 offen offset:2048 sc1
    v_mfma_f32_16x16x32_bf16 v[68:71], a[24:27], v[236:239], v[68:71]
    v_mfma_f32_16x16x32_bf16 v[72:75], a[28:31], v[232:235], v[72:75]
    v_mfma_f32_16x16x32_bf16 v[76:79], a[28:31], v[236:239], v[76:79]
    s_waitcnt lgkmcnt(2)
    v_mfma_f32_16x16x32_bf16 v[64:67], a[0:3], v[240:243], v[64:67]
    buffer_load_dwordx4 a[184:187], v3, s[36:39], s98 offen offset:3072 sc1
    v_mfma_f32_16x16x32_bf16 v[68:71], a[0:3], v[244:247], v[68:71]
    v_mfma_f32_16x16x32_bf16 v[72:75], a[4:7], v[240:243], v[72:75]
    v_mfma_f32_16x16x32_bf16 v[76:79], a[4:7], v[244:247], v[76:79]
    s_waitcnt lgkmcnt(1)
    v_mfma_f32_16x16x32_bf16 v[64:67], a[8:11], v[248:251], v[64:67]
    s_add_u32 s98, s98, 4096
    buffer_load_dwordx4 a[188:191], v3, s[36:39], s98 offen offset:0 sc1
    v_mfma_f32_16x16x32_bf16 v[68:71], a[8:11], v[252:255], v[68:71]
    s_waitcnt lgkmcnt(0)
    v_mfma_f32_16x16x32_bf16 v[72:75], a[12:15], v[248:251], v[72:75]
    v_mfma_f32_16x16x32_bf16 v[76:79], a[12:15], v[252:255], v[76:79]
    ds_read_b128 v[88:91], v10 offset:256
    ds_read_b128 v[92:95], v10 offset:704
    s_waitcnt lgkmcnt(0)
    v_pk_fma_f32 v[24:25], v[88:89], v[14:15], v[92:93] op_sel_hi:[1,0,1]
    s_add_u32 s98, s99, 40960
    buffer_load_dwordx4 a[192:195], v3, s[36:39], s98 offen offset:0 sc1
    v_pk_fma_f32 v[26:27], v[90:91], v[14:15], v[94:95] op_sel_hi:[1,0,1]
    v_pk_fma_f32 v[24:25], v[64:65], v[12:13], v[24:25] op_sel_hi:[1,0,1]
    v_pk_fma_f32 v[26:27], v[66:67], v[12:13], v[26:27] op_sel_hi:[1,0,1]
    v_exp_f32 v64, v24
    v_exp_f32 v65, v25
    v_exp_f32 v66, v26
    buffer_load_dwordx4 a[196:199], v3, s[36:39], s98 offen offset:1024 sc1
    v_exp_f32 v67, v27
    v_pk_add_f32 v[64:65], v[64:65], 1.0 op_sel_hi:[1,0]
    v_pk_add_f32 v[66:67], v[66:67], 1.0 op_sel_hi:[1,0]
    v_rcp_f32 v64, v64
    v_rcp_f32 v65, v65
    v_rcp_f32 v66, v66
    buffer_load_dwordx4 a[200:203], v3, s[36:39], s98 offen offset:2048 sc1
    v_rcp_f32 v67, v67
    v_pk_mul_f32 v[64:65], v[64:65], v[24:25]
    v_pk_mul_f32 v[66:67], v[66:67], v[26:27]
    v_cvt_pk_bf16_f32 v64, v64, v65
    v_cvt_pk_bf16_f32 v65, v66, v67
    v_pk_fma_f32 v[28:29], v[88:89], v[14:15], v[92:93] op_sel:[0,1,0] op_sel_hi:[1,1,1]
    buffer_load_dwordx4 a[204:207], v3, s[36:39], s98 offen offset:3072 sc1
    v_pk_fma_f32 v[30:31], v[90:91], v[14:15], v[94:95] op_sel:[0,1,0] op_sel_hi:[1,1,1]
    v_pk_fma_f32 v[28:29], v[68:69], v[12:13], v[28:29] op_sel:[0,1,0] op_sel_hi:[1,1,1]
    v_pk_fma_f32 v[30:31], v[70:71], v[12:13], v[30:31] op_sel:[0,1,0] op_sel_hi:[1,1,1]
    v_exp_f32 v68, v28
    v_exp_f32 v69, v29
    v_exp_f32 v70, v30
    s_add_u32 s98, s98, 4096
    buffer_load_dwordx4 a[208:211], v3, s[36:39], s98 offen offset:0 sc1
    v_exp_f32 v71, v31
    v_pk_add_f32 v[68:69], v[68:69], 1.0 op_sel_hi:[1,0]
    v_pk_add_f32 v[70:71], v[70:71], 1.0 op_sel_hi:[1,0]
    v_rcp_f32 v68, v68
    v_rcp_f32 v69, v69
    v_rcp_f32 v70, v70
    s_add_u32 s98, s99, 46080
    buffer_load_dwordx4 a[212:215], v3, s[36:39], s98 offen offset:0 sc1
    v_rcp_f32 v71, v71
    v_pk_mul_f32 v[68:69], v[68:69], v[28:29]
    v_pk_mul_f32 v[70:71], v[70:71], v[30:31]
    v_cvt_pk_bf16_f32 v68, v68, v69
    v_cvt_pk_bf16_f32 v69, v70, v71
    ds_read_b128 v[16:19], v10 offset:320
    buffer_load_dwordx4 a[216:219], v3, s[36:39], s98 offen offset:1024 sc1
    ds_read_b128 v[20:23], v10 offset:768
    s_waitcnt lgkmcnt(0)
    v_pk_fma_f32 v[24:25], v[16:17], v[14:15], v[20:21] op_sel_hi:[1,0,1]
    v_pk_fma_f32 v[26:27], v[18:19], v[14:15], v[22:23] op_sel_hi:[1,0,1]
    v_pk_fma_f32 v[24:25], v[72:73], v[12:13], v[24:25] op_sel_hi:[1,0,1]
    v_pk_fma_f32 v[26:27], v[74:75], v[12:13], v[26:27] op_sel_hi:[1,0,1]
    v_exp_f32 v72, v24
    buffer_load_dwordx4 a[220:223], v3, s[36:39], s98 offen offset:2048 sc1
    v_exp_f32 v73, v25
    v_exp_f32 v74, v26
    v_exp_f32 v75, v27
    v_pk_add_f32 v[72:73], v[72:73], 1.0 op_sel_hi:[1,0]
    v_pk_add_f32 v[74:75], v[74:75], 1.0 op_sel_hi:[1,0]
    v_rcp_f32 v72, v72
    buffer_load_dwordx4 a[224:227], v3, s[36:39], s98 offen offset:3072 sc1
    v_rcp_f32 v73, v73
    v_rcp_f32 v74, v74
    v_rcp_f32 v75, v75
    v_pk_mul_f32 v[72:73], v[72:73], v[24:25]
    v_pk_mul_f32 v[74:75], v[74:75], v[26:27]
    v_cvt_pk_bf16_f32 v66, v72, v73
    s_add_u32 s98, s98, 4096
    buffer_load_dwordx4 a[228:231], v3, s[36:39], s98 offen offset:0 sc1
    v_cvt_pk_bf16_f32 v67, v74, v75
    buffer_store_dwordx4 v[64:67], v3, s[36:39], s74 offen offset:2048 sc1
    v_pk_fma_f32 v[28:29], v[16:17], v[14:15], v[20:21] op_sel:[0,1,0] op_sel_hi:[1,1,1]
    v_pk_fma_f32 v[30:31], v[18:19], v[14:15], v[22:23] op_sel:[0,1,0] op_sel_hi:[1,1,1]
    v_pk_fma_f32 v[28:29], v[76:77], v[12:13], v[28:29] op_sel:[0,1,0] op_sel_hi:[1,1,1]
    v_pk_fma_f32 v[30:31], v[78:79], v[12:13], v[30:31] op_sel:[0,1,0] op_sel_hi:[1,1,1]
    s_add_u32 s98, s99, 51200
    buffer_load_dwordx4 a[232:235], v3, s[36:39], s98 offen offset:0 sc1
    v_exp_f32 v76, v28
    v_exp_f32 v77, v29
    v_exp_f32 v78, v30
    v_exp_f32 v79, v31
    v_pk_add_f32 v[76:77], v[76:77], 1.0 op_sel_hi:[1,0]
    v_pk_add_f32 v[78:79], v[78:79], 1.0 op_sel_hi:[1,0]
    buffer_load_dwordx4 a[236:239], v3, s[36:39], s98 offen offset:1024 sc1
    v_rcp_f32 v76, v76
    v_rcp_f32 v77, v77
    v_rcp_f32 v78, v78
    v_rcp_f32 v79, v79
    v_pk_mul_f32 v[76:77], v[76:77], v[28:29]
    v_pk_mul_f32 v[78:79], v[78:79], v[30:31]
    v_cvt_pk_bf16_f32 v70, v76, v77
    v_cvt_pk_bf16_f32 v71, v78, v79
    buffer_store_dwordx4 v[68:71], v3, s[36:39], s75 offen offset:2048 sc1
    v_mov_b32 v11, s34
    s_waitcnt vmcnt(0)
    s_barrier
    buffer_store_dword v11, v0, s[36:39], s40 offen sc1
    buffer_load_dwordx4 a[240:243], v3, s[36:39], s98 offen offset:2048 sc1
    buffer_load_dwordx4 a[244:247], v3, s[36:39], s98 offen offset:3072 sc1
    s_add_u32 s98, s98, 4096
    buffer_load_dwordx4 a[248:251], v3, s[36:39], s98 offen offset:0 sc1
    s_add_u32 s98, s99, 56320
    buffer_load_dwordx4 a[252:255], v3, s[36:39], s98 offen offset:0 sc1
    buffer_load_dwordx4 v[96:99], v3, s[36:39], s98 offen offset:1024 sc1
    buffer_load_dwordx4 v[100:103], v3, s[36:39], s98 offen offset:2048 sc1
    buffer_load_dwordx4 v[104:107], v3, s[36:39], s98 offen offset:3072 sc1
    s_add_u32 s98, s98, 4096
    buffer_load_dwordx4 v[108:111], v3, s[36:39], s98 offen offset:0 sc1
    v_mov_b32 v255, 0
    buffer_atomic_or v255, v1, s[36:39], s44 offen sc0 sc1
    s_add_u32 s98, s99, 61440
    buffer_load_dwordx4 v[112:115], v3, s[36:39], s98 offen offset:0 sc1
    buffer_load_dwordx4 v[116:119], v3, s[36:39], s98 offen offset:1024 sc1
    buffer_load_dwordx4 v[120:123], v3, s[36:39], s98 offen offset:2048 sc1
    buffer_load_dwordx4 v[124:127], v3, s[36:39], s98 offen offset:3072 sc1
    s_add_u32 s98, s98, 4096
    buffer_load_dwordx4 v[128:131], v3, s[36:39], s98 offen offset:0 sc1
    s_add_u32 s98, s99, 66560
    buffer_load_dwordx4 v[132:135], v3, s[36:39], s98 offen offset:0 sc1
    buffer_load_dwordx4 v[136:139], v3, s[36:39], s98 offen offset:1024 sc1
    buffer_load_dwordx4 v[140:143], v3, s[36:39], s98 offen offset:2048 sc1
    buffer_load_dwordx4 v[144:147], v3, s[36:39], s98 offen offset:3072 sc1
    s_add_u32 s98, s98, 4096
    buffer_load_dwordx4 v[148:151], v3, s[36:39], s98 offen offset:0 sc1
    v_lshrrev_b32 v5, 8, v3
    v_bfe_u32 v6, v3, 4, 4
    v_add_u32 v7, s84, v3
    v_add_u32 v8, s85, v3
    v_add_u32 v9, s86, v3
    v_add_u32 v4, s87, v3
    v_lshlrev_b32 v80, 4, v6
    v_lshl_add_u32 v81, v5, 14, v80
    v_lshl_add_u32 v80, v5, 15, v80
    s_mul_i32 s76, s95, 327680
    s_lshl_b32 s77, s94, 1
    s_lshr_b32 s78, s88, 1
    s_add_u32 s77, s77, s78
    s_lshl_b32 s77, s77, 8
    s_add_u32 s76, s76, s77
    s_and_b32 s78, s88, 1
    s_lshl_b32 s78, s78, 3
    s_add_u32 s76, s76, s78
    s_add_u32 s79, s76, 0x600000
    v_lshlrev_b32 v82, 5, v5
    v_lshlrev_b32 v83, 4, v5
    s_mul_i32 s78, s95, 320
    s_add_u32 s78, s78, 0x56000
    s_lshr_b32 s76, s94, 2
    s_lshl_b32 s76, s76, 8
    s_and_b32 s77, s94, 2
    s_add_u32 s76, s76, s77
    s_and_b32 s77, s94, 1
    s_lshl4_add_u32 s76, s77, s76
    s_lshr_b32 s77, s88, 1
    s_lshl3_add_u32 s76, s77, s76
    s_and_b32 s77, s88, 1
    s_add_u32 s76, s76, s77
    s_mul_i32 s76, s76, 1280
    s_mul_i32 s77, s95, 160
    s_add_u32 s76, s76, s77
    v_and_b32 v12, 7, v6
    v_lshrrev_b32 v13, 3, v6
    v_lshlrev_b32 v12, 5, v12
    v_lshl_add_u32 v12, v13, 2, v12
    v_mul_u32_u24 v12, 1280, v12
    v_lshl_add_u32 v6, v5, 3, v12
    v_lshl_add_u32 v5, v5, 4, v12
    s_waitcnt vmcnt(10)
    v_cmp_ne_u32 s[56:57], s34, v255
    s_nop 1
    s_and_b32 s56, s56, 15
    s_cbranch_scc0 F_t30
    s_mov_b32 s97, 0
F_t30_l:
    v_mov_b32 v255, 0
    buffer_atomic_or v255, v1, s[36:39], s44 offen sc0 sc1
    s_add_u32 s97, s97, 1
    s_waitcnt vmcnt(0)
    v_cmp_ne_u32 s[56:57], s34, v255
    s_nop 1
    s_and_b32 s56, s56, 15
    s_cbranch_scc0 F_t30
    s_cmp_lt_u32 s97, 0x40000
    s_cbranch_scc1 F_t30_l
F_t30:
    s_add_u32 s71, s80, 0
    buffer_load_dwordx4 v[152:155], v3, s[36:39], s71 offen offset:0 sc1
    s_add_u32 s71, s80, 0
    buffer_load_dwordx4 v[156:159], v3, s[36:39], s71 offen offset:1024 sc1
    s_add_u32 s71, s80, 0
    buffer_load_dwordx4 v[160:163], v3, s[36:39], s71 offen offset:2048 sc1
    s_add_u32 s71, s80, 0
    buffer_load_dwordx4 v[164:167], v3, s[36:39], s71 offen offset:3072 sc1
    s_add_u32 s71, s80, 4096
    buffer_load_dwordx4 v[168:171], v3, s[36:39], s71 offen offset:0 sc1
    s_add_u32 s71, s80, 4096
    buffer_load_dwordx4 v[172:175], v3, s[36:39], s71 offen offset:1024 sc1
    s_add_u32 s71, s80, 4096
    buffer_load_dwordx4 v[176:179], v3, s[36:39], s71 offen offset:2048 sc1
    s_add_u32 s71, s80, 4096
    buffer_load_dwordx4 v[180:183], v3, s[36:39], s71 offen offset:3072 sc1
    s_add_u32 s71, s80, 8192
    buffer_load_dwordx4 v[184:187], v3, s[36:39], s71 offen offset:0 sc1
    s_add_u32 s71, s80, 8192
    buffer_load_dwordx4 v[188:191], v3, s[36:39], s71 offen offset:1024 sc1
    s_add_u32 s71, s80, 8192
    buffer_load_dwordx4 v[192:195], v3, s[36:39], s71 offen offset:2048 sc1
    s_add_u32 s71, s80, 8192
    buffer_load_dwordx4 v[196:199], v3, s[36:39], s71 offen offset:3072 sc1
    s_add_u32 s71, s80, 12288
    buffer_load_dwordx4 v[200:203], v3, s[36:39], s71 offen offset:0 sc1
    s_add_u32 s71, s80, 12288
    buffer_load_dwordx4 v[204:207], v3, s[36:39], s71 offen offset:1024 sc1
    s_mov_b32 s40, s28
    s_mov_b32 s41, s29
    s_mov_b32 s42, 2621440
    s_mov_b32 s43, 0x20000
    s_waitcnt vmcnt(13)
    v_mfma_f32_16x16x32_bf16 v[40:43], a[32:35], v[152:155], 0
    s_add_u32 s71, s81, 0
    buffer_load_dwordx4 v[208:211], v3, s[36:39], s71 offen offset:0 sc1
    v_mfma_f32_16x16x32_bf16 v[44:47], a[36:39], v[152:155], 0
    v_mfma_f32_16x16x32_bf16 v[48:51], a[40:43], v[152:155], 0
    v_mfma_f32_16x16x32_bf16 v[52:55], a[44:47], v[152:155], 0
    v_mfma_f32_16x16x32_bf16 v[56:59], a[48:51], v[152:155], 0
    s_waitcnt vmcnt(13)
    s_add_u32 s71, s81, 0
    v_mfma_f32_16x16x32_bf16 v[40:43], a[52:55], v[156:159], v[40:43]
    buffer_load_dwordx4 v[212:215], v3, s[36:39], s71 offen offset:1024 sc1
    v_mfma_f32_16x16x32_bf16 v[44:47], a[56:59], v[156:159], v[44:47]
    v_mfma_f32_16x16x32_bf16 v[48:51], a[60:63], v[156:159], v[48:51]
    v_mfma_f32_16x16x32_bf16 v[52:55], a[64:67], v[156:159], v[52:55]
    s_add_u32 s71, s81, 0
    buffer_load_dwordx4 v[216:219], v3, s[36:39], s71 offen offset:2048 sc1
    v_mfma_f32_16x16x32_bf16 v[56:59], a[68:71], v[156:159], v[56:59]
    s_waitcnt vmcnt(14)
    v_mfma_f32_16x16x32_bf16 v[40:43], a[72:75], v[160:163], v[40:43]
    v_mfma_f32_16x16x32_bf16 v[44:47], a[76:79], v[160:163], v[44:47]
    v_mfma_f32_16x16x32_bf16 v[48:51], a[80:83], v[160:163], v[48:51]
    s_add_u32 s71, s81, 0
    buffer_load_dwordx4 v[220:223], v3, s[36:39], s71 offen offset:3072 sc1
    v_mfma_f32_16x16x32_bf16 v[52:55], a[84:87], v[160:163], v[52:55]
    v_mfma_f32_16x16x32_bf16 v[56:59], a[88:91], v[160:163], v[56:59]
    s_waitcnt vmcnt(14)
    v_mfma_f32_16x16x32_bf16 v[40:43], a[92:95], v[164:167], v[40:43]
    v_mfma_f32_16x16x32_bf16 v[44:47], a[96:99], v[164:167], v[44:47]
    s_add_u32 s71, s81, 4096
    buffer_load_dwordx4 v[224:227], v3, s[36:39], s71 offen offset:0 sc1
    v_mfma_f32_16x16x32_bf16 v[48:51], a[100:103], v[164:167], v[48:51]
    v_mfma_f32_16x16x32_bf16 v[52:55], a[104:107], v[164:167], v[52:55]
    v_mfma_f32_16x16x32_bf16 v[56:59], a[108:111], v[164:167], v[56:59]
    s_waitcnt vmcnt(14)
    v_mfma_f32_16x16x32_bf16 v[40:43], a[112:115], v[168:171], v[40:43]
    s_add_u32 s71, s81, 4096
    buffer_load_dwordx4 v[228:231], v3, s[36:39], s71 offen offset:1024 sc1
    v_mfma_f32_16x16x32_bf16 v[44:47], a[116:119], v[168:171], v[44:47]
    v_mfma_f32_16x16x32_bf16 v[48:51], a[120:123], v[168:171], v[48:51]
    v_mfma_f32_16x16x32_bf16 v[52:55], a[124:127], v[168:171], v[52:55]
    v_mfma_f32_16x16x32_bf16 v[56:59], a[128:131], v[168:171], v[56:59]
    s_waitcnt vmcnt(14)
    s_add_u32 s71, s81, 4096
    v_mfma_f32_16x16x32_bf16 v[40:43], a[132:135], v[172:175], v[40:43]
    buffer_load_dwordx4 v[152:155], v3, s[36:39], s71 offen offset:2048 sc1
    v_mfma_f32_16x16x32_bf16 v[44:47], a[136:139], v[172:175], v[44:47]
    v_mfma_f32_16x16x32_bf16 v[48:51], a[140:143], v[172:175], v[48:51]
    v_mfma_f32_16x16x32_bf16 v[52:55], a[144:147], v[172:175], v[52:55]
    s_add_u32 s71, s81, 4096
    buffer_load_dwordx4 v[156:159], v3, s[36:39], s71 offen offset:3072 sc1
    v_mfma_f32_16x16x32_bf16 v[56:59], a[148:151], v[172:175], v[56:59]
    s_waitcnt vmcnt(15)
    v_mfma_f32_16x16x32_bf16 v[40:43], a[152:155], v[176:179], v[40:43]
    v_mfma_f32_16x16x32_bf16 v[44:47], a[156:159], v[176:179], v[44:47]
    v_mfma_f32_16x16x32_bf16 v[48:51], a[160:163], v[176:179], v[48:51]
    s_add_u32 s71, s81, 8192
    buffer_load_dwordx4 v[160:163], v3, s[36:39], s71 offen offset:0 sc1
    v_mfma_f32_16x16x32_bf16 v[52:55], a[164:167], v[176:179], v[52:55]
    v_mfma_f32_16x16x32_bf16 v[56:59], a[168:171], v[176:179], v[56:59]
    s_waitcnt vmcnt(15)
    v_mfma_f32_16x16x32_bf16 v[40:43], a[172:175], v[180:183], v[40:43]
    v_mfma_f32_16x16x32_bf16 v[44:47], a[176:179], v[180:183], v[44:47]
    s_add_u32 s71, s81, 8192
    buffer_load_dwordx4 v[164:167], v3, s[36:39], s71 offen offset:1024 sc1
    v_mfma_f32_16x16x32_bf16 v[48:51], a[180:183], v[180:183], v[48:51]
    v_mfma_f32_16x16x32_bf16 v[52:55], a[184:187], v[180:183], v[52:55]
    v_mfma_f32_16x16x32_bf16 v[56:59], a[188:191], v[180:183], v[56:59]
    s_waitcnt vmcnt(15)
    v_mfma_f32_16x16x32_bf16 v[40:43], a[192:195], v[184:187], v[40:43]
    s_add_u32 s71, s81, 8192
    buffer_load_dwordx4 v[168:171], v3, s[36:39], s71 offen offset:2048 sc1
    v_mfma_f32_16x16x32_bf16 v[44:47], a[196:199], v[184:187], v[44:47]
    v_mfma_f32_16x16x32_bf16 v[48:51], a[200:203], v[184:187], v[48:51]
    v_mfma_f32_16x16x32_bf16 v[52:55], a[204:207], v[184:187], v[52:55]
    v_mfma_f32_16x16x32_bf16 v[56:59], a[208:211], v[184:187], v[56:59]
    s_waitcnt vmcnt(15)
    s_add_u32 s71, s81, 8192
    v_mfma_f32_16x16x32_bf16 v[40:43], a[212:215], v[188:191], v[40:43]
    buffer_load_dwordx4 v[172:175], v3, s[36:39], s71 offen offset:3072 sc1
    v_mfma_f32_16x16x32_bf16 v[44:47], a[216:219], v[188:191], v[44:47]
    v_mfma_f32_16x16x32_bf16 v[48:51], a[220:223], v[188:191], v[48:51]
    v_mfma_f32_16x16x32_bf16 v[52:55], a[224:227], v[188:191], v[52:55]
    s_add_u32 s71, s81, 12288
    buffer_load_dwordx4 v[176:179], v3, s[36:39], s71 offen offset:0 sc1
    v_mfma_f32_16x16x32_bf16 v[56:59], a[228:231], v[188:191], v[56:59]
    s_waitcnt vmcnt(16)
    v_mfma_f32_16x16x32_bf16 v[40:43], a[232:235], v[192:195], v[40:43]
    v_mfma_f32_16x16x32_bf16 v[44:47], a[236:239], v[192:195], v[44:47]
    v_mfma_f32_16x16x32_bf16 v[48:51], a[240:243], v[192:195], v[48:51]
    s_add_u32 s71, s81, 12288
    buffer_load_dwordx4 v[180:183], v3, s[36:39], s71 offen offset:1024 sc1
    v_mfma_f32_16x16x32_bf16 v[52:55], a[244:247], v[192:195], v[52:55]
    v_mfma_f32_16x16x32_bf16 v[56:59], a[248:251], v[192:195], v[56:59]
    s_waitcnt vmcnt(16)
    v_mfma_f32_16x16x32_bf16 v[40:43], a[252:255], v[196:199], v[40:43]
    v_mfma_f32_16x16x32_bf16 v[44:47], v[96:99], v[196:199], v[44:47]
    s_add_u32 s71, s82, 0
    buffer_load_dwordx4 v[184:187], v3, s[36:39], s71 offen offset:0 sc1
    v_mfma_f32_16x16x32_bf16 v[48:51], v[100:103], v[196:199], v[48:51]
    v_mfma_f32_16x16x32_bf16 v[52:55], v[104:107], v[196:199], v[52:55]
    v_mfma_f32_16x16x32_bf16 v[56:59], v[108:111], v[196:199], v[56:59]
    s_waitcnt vmcnt(16)
    v_mfma_f32_16x16x32_bf16 v[40:43], v[112:115], v[200:203], v[40:43]
    s_add_u32 s71, s82, 0
    buffer_load_dwordx4 v[188:191], v3, s[36:39], s71 offen offset:1024 sc1
    v_mfma_f32_16x16x32_bf16 v[44:47], v[116:119], v[200:203], v[44:47]
    v_mfma_f32_16x16x32_bf16 v[48:51], v[120:123], v[200:203], v[48:51]
    v_mfma_f32_16x16x32_bf16 v[52:55], v[124:127], v[200:203], v[52:55]
    v_mfma_f32_16x16x32_bf16 v[56:59], v[128:131], v[200:203], v[56:59]
    s_waitcnt vmcnt(16)
    s_add_u32 s71, s82, 0
    v_mfma_f32_16x16x32_bf16 v[40:43], v[132:135], v[204:207], v[40:43]
    buffer_load_dwordx4 v[192:195], v3, s[36:39], s71 offen offset:2048 sc1
    v_mfma_f32_16x16x32_bf16 v[44:47], v[136:139], v[204:207], v[44:47]
    v_mfma_f32_16x16x32_bf16 v[48:51], v[140:143], v[204:207], v[48:51]
    v_mfma_f32_16x16x32_bf16 v[52:55], v[144:147], v[204:207], v[52:55]
    s_add_u32 s71, s82, 0
    buffer_load_dwordx4 v[196:199], v3, s[36:39], s71 offen offset:3072 sc1
    v_mfma_f32_16x16x32_bf16 v[56:59], v[148:151], v[204:207], v[56:59]
    s_waitcnt vmcnt(17)
    v_mfma_f32_16x16x32_bf16 v[60:63], a[32:35], v[208:211], 0
    v_mfma_f32_16x16x32_bf16 v[64:67], a[36:39], v[208:211], 0
    v_mfma_f32_16x16x32_bf16 v[68:71], a[40:43], v[208:211], 0
    ds_write_b128 v7, v[40:43] offset:0
    v_mfma_f32_16x16x32_bf16 v[72:75], a[44:47], v[208:211], 0
    s_add_u32 s71, s82, 4096
    buffer_load_dwordx4 v[200:203], v3, s[36:39], s71 offen offset:0 sc1
    v_mfma_f32_16x16x32_bf16 v[76:79], a[48:51], v[208:211], 0
    s_waitcnt vmcnt(17)
    v_mfma_f32_16x16x32_bf16 v[60:63], a[52:55], v[212:215], v[60:63]
    ds_write_b128 v7, v[44:47] offset:1024
    v_mfma_f32_16x16x32_bf16 v[64:67], a[56:59], v[212:215], v[64:67]
    s_add_u32 s71, s82, 4096
    buffer_load_dwordx4 v[204:207], v3, s[36:39], s71 offen offset:1024 sc1
    v_mfma_f32_16x16x32_bf16 v[68:71], a[60:63], v[212:215], v[68:71]
    v_mfma_f32_16x16x32_bf16 v[72:75], a[64:67], v[212:215], v[72:75]
    ds_write_b128 v7, v[48:51] offset:2048
    v_mfma_f32_16x16x32_bf16 v[76:79], a[68:71], v[212:215], v[76:79]
    s_waitcnt vmcnt(17)
    v_mfma_f32_16x16x32_bf16 v[60:63], a[72:75], v[216:219], v[60:63]
    s_add_u32 s71, s82, 4096
    buffer_load_dwordx4 v[208:211], v3, s[36:39], s71 offen offset:2048 sc1
    v_mfma_f32_16x16x32_bf16 v[64:67], a[76:79], v[216:219], v[64:67]
    ds_write_b128 v7, v[52:55] offset:3072
    v_mfma_f32_16x16x32_bf16 v[68:71], a[80:83], v[216:219], v[68:71]
    v_mfma_f32_16x16x32_bf16 v[72:75], a[84:87], v[216:219], v[72:75]
    v_mfma_f32_16x16x32_bf16 v[76:79], a[88:91], v[216:219], v[76:79]
    ds_write_b128 v7, v[56:59] offset:4096
    s_waitcnt vmcnt(17)
    v_mfma_f32_16x16x32_bf16 v[60:63], a[92:95], v[220:223], v[60:63]
    s_add_u32 s71, s82, 4096
    buffer_load_dwordx4 v[212:215], v3, s[36:39], s71 offen offset:3072 sc1
    v_mfma_f32_16x16x32_bf16 v[64:67], a[96:99], v[220:223], v[64:67]
    v_mfma_f32_16x16x32_bf16 v[68:71], a[100:103], v[220:223], v[68:71]
    v_mfma_f32_16x16x32_bf16 v[72:75], a[104:107], v[220:223], v[72:75]
    s_add_u32 s71, s82, 8192
    buffer_load_dwordx4 v[216:219], v3, s[36:39], s71 offen offset:0 sc1
    v_mfma_f32_16x16x32_bf16 v[76:79], a[108:111], v[220:223], v[76:79]
    s_waitcnt vmcnt(18)
    v_mfma_f32_16x16x32_bf16 v[60:63], a[112:115], v[224:227], v[60:63]
    v_mfma_f32_16x16x32_bf16 v[64:67], a[116:119], v[224:227], v[64:67]
    v_mfma_f32_16x16x32_bf16 v[68:71], a[120:123], v[224:227], v[68:71]
    s_add_u32 s71, s82, 8192
    buffer_load_dwordx4 v[220:223], v3, s[36:39], s71 offen offset:1024 sc1
    v_mfma_f32_16x16x32_bf16 v[72:75], a[124:127], v[224:227], v[72:75]
    v_mfma_f32_16x16x32_bf16 v[76:79], a[128:131], v[224:227], v[76:79]
    s_waitcnt vmcnt(18)
    v_mfma_f32_16x16x32_bf16 v[60:63], a[132:135], v[228:231], v[60:63]
    v_mfma_f32_16x16x32_bf16 v[64:67], a[136:139], v[228:231], v[64:67]
    s_add_u32 s71, s82, 8192
    buffer_load_dwordx4 v[224:227], v3, s[36:39], s71 offen offset:2048 sc1
    v_mfma_f32_16x16x32_bf16 v[68:71], a[140:143], v[228:231], v[68:71]
    v_mfma_f32_16x16x32_bf16 v[72:75], a[144:147], v[228:231], v[72:75]
    v_mfma_f32_16x16x32_bf16 v[76:79], a[148:151], v[228:231], v[76:79]
    s_waitcnt vmcnt(18)
    v_mfma_f32_16x16x32_bf16 v[60:63], a[152:155], v[152:155], v[60:63]
    s_add_u32 s71, s82, 8192
    buffer_load_dwordx4 v[228:231], v3, s[36:39], s71 offen offset:3072 sc1
    v_mfma_f32_16x16x32_bf16 v[64:67], a[156:159], v[152:155], v[64:67]
    v_mfma_f32_16x16x32_bf16 v[68:71], a[160:163], v[152:155], v[68:71]
    v_mfma_f32_16x16x32_bf16 v[72:75], a[164:167], v[152:155], v[72:75]
    v_mfma_f32_16x16x32_bf16 v[76:79], a[168:171], v[152:155], v[76:79]
    s_waitcnt vmcnt(18)
    s_add_u32 s71, s82, 12288
    v_mfma_f32_16x16x32_bf16 v[60:63], a[172:175], v[156:159], v[60:63]
    buffer_load_dwordx4 v[152:155], v3, s[36:39], s71 offen offset:0 sc1
    v_mfma_f32_16x16x32_bf16 v[64:67], a[176:179], v[156:159], v[64:67]
    v_mfma_f32_16x16x32_bf16 v[68:71], a[180:183], v[156:159], v[68:71]
    v_mfma_f32_16x16x32_bf16 v[72:75], a[184:187], v[156:159], v[72:75]
    v_mfma_f32_16x16x32_bf16 v[76:79], a[188:191], v[156:159], v[76:79]
    s_waitcnt vmcnt(18)
    s_add_u32 s71, s82, 12288
    v_mfma_f32_16x16x32_bf16 v[60:63], a[192:195], v[160:163], v[60:63]
    buffer_load_dwordx4 v[156:159], v3, s[36:39], s71 offen offset:1024 sc1
    v_mfma_f32_16x16x32_bf16 v[64:67], a[196:199], v[160:163], v[64:67]
    v_mfma_f32_16x16x32_bf16 v[68:71], a[200:203], v[160:163], v[68:71]
    v_mfma_f32_16x16x32_bf16 v[72:75], a[204:207], v[160:163], v[72:75]
    v_mfma_f32_16x16x32_bf16 v[76:79], a[208:211], v[160:163], v[76:79]
    s_waitcnt vmcnt(18)
    s_add_u32 s71, s83, 0
    v_mfma_f32_16x16x32_bf16 v[60:63], a[212:215], v[164:167], v[60:63]
    buffer_load_dwordx4 v[160:163], v3, s[36:39], s71 offen offset:0 sc1
    v_mfma_f32_16x16x32_bf16 v[64:67], a[216:219], v[164:167], v[64:67]
    v_mfma_f32_16x16x32_bf16 v[68:71], a[220:223], v[164:167], v[68:71]
    v_mfma_f32_16x16x32_bf16 v[72:75], a[224:227], v[164:167], v[72:75]
    v_mfma_f32_16x16x32_bf16 v[76:79], a[228:231], v[164:167], v[76:79]
    s_waitcnt vmcnt(18)
    s_add_u32 s71, s83, 0
    v_mfma_f32_16x16x32_bf16 v[60:63], a[232:235], v[168:171], v[60:63]
    buffer_load_dwordx4 v[164:167], v3, s[36:39], s71 offen offset:1024 sc1
    v_mfma_f32_16x16x32_bf16 v[64:67], a[236:239], v[168:171], v[64:67]
    v_mfma_f32_16x16x32_bf16 v[68:71], a[240:243], v[168:171], v[68:71]
    v_mfma_f32_16x16x32_bf16 v[72:75], a[244:247], v[168:171], v[72:75]
    v_mfma_f32_16x16x32_bf16 v[76:79], a[248:251], v[168:171], v[76:79]
    s_waitcnt vmcnt(18)
    s_add_u32 s71, s83, 0
    v_mfma_f32_16x16x32_bf16 v[60:63], a[252:255], v[172:175], v[60:63]
    buffer_load_dwordx4 v[168:171], v3, s[36:39], s71 offen offset:2048 sc1
    v_mfma_f32_16x16x32_bf16 v[64:67], v[96:99], v[172:175], v[64:67]
    v_mfma_f32_16x16x32_bf16 v[68:71], v[100:103], v[172:175], v[68:71]
    v_mfma_f32_16x16x32_bf16 v[72:75], v[104:107], v[172:175], v[72:75]
    v_mfma_f32_16x16x32_bf16 v[76:79], v[108:111], v[172:175], v[76:79]
    s_waitcnt vmcnt(18)
    s_add_u32 s71, s83, 0
    v_mfma_f32_16x16x32_bf16 v[60:63], v[112:115], v[176:179], v[60:63]
    buffer_load_dwordx4 v[172:175], v3, s[36:39], s71 offen offset:3072 sc1
    v_mfma_f32_16x16x32_bf16 v[64:67], v[116:119], v[176:179], v[64:67]
    v_mfma_f32_16x16x32_bf16 v[68:71], v[120:123], v[176:179], v[68:71]
    v_mfma_f32_16x16x32_bf16 v[72:75], v[124:127], v[176:179], v[72:75]
    v_mfma_f32_16x16x32_bf16 v[76:79], v[128:131], v[176:179], v[76:79]
    s_waitcnt vmcnt(18)
    s_add_u32 s71, s83, 4096
    v_mfma_f32_16x16x32_bf16 v[60:63], v[132:135], v[180:183], v[60:63]
    buffer_load_dwordx4 v[176:179], v3, s[36:39], s71 offen offset:0 sc1
    v_mfma_f32_16x16x32_bf16 v[64:67], v[136:139], v[180:183], v[64:67]
    v_mfma_f32_16x16x32_bf16 v[68:71], v[140:143], v[180:183], v[68:71]
    v_mfma_f32_16x16x32_bf16 v[72:75], v[144:147], v[180:183], v[72:75]
    v_mfma_f32_16x16x32_bf16 v[76:79], v[148:151], v[180:183], v[76:79]
    s_waitcnt vmcnt(18)
    s_add_u32 s71, s83, 4096
    v_mfma_f32_16x16x32_bf16 v[40:43], a[32:35], v[184:187], 0
    buffer_load_dwordx4 v[180:183], v3, s[36:39], s71 offen offset:1024 sc1
    v_mfma_f32_16x16x32_bf16 v[44:47], a[36:39], v[184:187], 0
    v_mfma_f32_16x16x32_bf16 v[48:51], a[40:43], v[184:187], 0
    ds_write_b128 v8, v[60:63] offset:5120
    v_mfma_f32_16x16x32_bf16 v[52:55], a[44:47], v[184:187], 0
    v_mfma_f32_16x16x32_bf16 v[56:59], a[48:51], v[184:187], 0
    s_waitcnt vmcnt(18)
    s_add_u32 s71, s83, 4096
    v_mfma_f32_16x16x32_bf16 v[40:43], a[52:55], v[188:191], v[40:43]
    buffer_load_dwordx4 v[184:187], v3, s[36:39], s71 offen offset:2048 sc1
    v_mfma_f32_16x16x32_bf16 v[44:47], a[56:59], v[188:191], v[44:47]
    ds_write_b128 v8, v[64:67] offset:6144
    v_mfma_f32_16x16x32_bf16 v[48:51], a[60:63], v[188:191], v[48:51]
    v_mfma_f32_16x16x32_bf16 v[52:55], a[64:67], v[188:191], v[52:55]
    ds_write_b128 v8, v[68:71] offset:7168
    v_mfma_f32_16x16x32_bf16 v[56:59], a[68:71], v[188:191], v[56:59]
    s_waitcnt vmcnt(18)
    s_add_u32 s71, s83, 4096
    v_mfma_f32_16x16x32_bf16 v[40:43], a[72:75], v[192:195], v[40:43]
    buffer_load_dwordx4 v[188:191], v3, s[36:39], s71 offen offset:3072 sc1
    v_mfma_f32_16x16x32_bf16 v[44:47], a[76:79], v[192:195], v[44:47]
    ds_write_b128 v8, v[72:75] offset:8192
    v_mfma_f32_16x16x32_bf16 v[48:51], a[80:83], v[192:195], v[48:51]
    v_mfma_f32_16x16x32_bf16 v[52:55], a[84:87], v[192:195], v[52:55]
    v_mfma_f32_16x16x32_bf16 v[56:59], a[88:91], v[192:195], v[56:59]
    ds_write_b128 v8, v[76:79] offset:9216
    s_waitcnt vmcnt(18)
    v_mfma_f32_16x16x32_bf16 v[40:43], a[92:95], v[196:199], v[40:43]
    s_add_u32 s71, s83, 8192
    buffer_load_dwordx4 v[192:195], v3, s[36:39], s71 offen offset:0 sc1
    v_mfma_f32_16x16x32_bf16 v[44:47], a[96:99], v[196:199], v[44:47]
    v_mfma_f32_16x16x32_bf16 v[48:51], a[100:103], v[196:199], v[48:51]
    v_mfma_f32_16x16x32_bf16 v[52:55], a[104:107], v[196:199], v[52:55]
    v_mfma_f32_16x16x32_bf16 v[56:59], a[108:111], v[196:199], v[56:59]
    s_waitcnt vmcnt(18)
    s_add_u32 s71, s83, 8192
    v_mfma_f32_16x16x32_bf16 v[40:43], a[112:115], v[200:203], v[40:43]
    buffer_load_dwordx4 v[196:199], v3, s[36:39], s71 offen offset:1024 sc1
    v_mfma_f32_16x16x32_bf16 v[44:47], a[116:119], v[200:203], v[44:47]
    v_mfma_f32_16x16x32_bf16 v[48:51], a[120:123], v[200:203], v[48:51]
    v_mfma_f32_16x16x32_bf16 v[52:55], a[124:127], v[200:203], v[52:55]
    v_mfma_f32_16x16x32_bf16 v[56:59], a[128:131], v[200:203], v[56:59]
    s_waitcnt vmcnt(18)
    s_add_u32 s71, s83, 8192
    v_mfma_f32_16x16x32_bf16 v[40:43], a[132:135], v[204:207], v[40:43]
    buffer_load_dwordx4 v[200:203], v3, s[36:39], s71 offen offset:2048 sc1
    v_mfma_f32_16x16x32_bf16 v[44:47], a[136:139], v[204:207], v[44:47]
    v_mfma_f32_16x16x32_bf16 v[48:51], a[140:143], v[204:207], v[48:51]
    v_mfma_f32_16x16x32_bf16 v[52:55], a[144:147], v[204:207], v[52:55]
    v_mfma_f32_16x16x32_bf16 v[56:59], a[148:151], v[204:207], v[56:59]
    s_waitcnt vmcnt(18)
    s_add_u32 s71, s83, 8192
    v_mfma_f32_16x16x32_bf16 v[40:43], a[152:155], v[208:211], v[40:43]
    buffer_load_dwordx4 v[204:207], v3, s[36:39], s71 offen offset:3072 sc1
    v_mfma_f32_16x16x32_bf16 v[44:47], a[156:159], v[208:211], v[44:47]
    v_mfma_f32_16x16x32_bf16 v[48:51], a[160:163], v[208:211], v[48:51]
    v_mfma_f32_16x16x32_bf16 v[52:55], a[164:167], v[208:211], v[52:55]
    v_mfma_f32_16x16x32_bf16 v[56:59], a[168:171], v[208:211], v[56:59]
    s_waitcnt vmcnt(18)
    s_add_u32 s71, s83, 12288
    v_mfma_f32_16x16x32_bf16 v[40:43], a[172:175], v[212:215], v[40:43]
    buffer_load_dwordx4 v[208:211], v3, s[36:39], s71 offen offset:0 sc1
    v_mfma_f32_16x16x32_bf16 v[44:47], a[176:179], v[212:215], v[44:47]
    v_mfma_f32_16x16x32_bf16 v[48:51], a[180:183], v[212:215], v[48:51]
    v_mfma_f32_16x16x32_bf16 v[52:55], a[184:187], v[212:215], v[52:55]
    v_mfma_f32_16x16x32_bf16 v[56:59], a[188:191], v[212:215], v[56:59]
    s_waitcnt vmcnt(18)
    s_add_u32 s71, s83, 12288
    v_mfma_f32_16x16x32_bf16 v[40:43], a[192:195], v[216:219], v[40:43]
    buffer_load_dwordx4 v[212:215], v3, s[36:39], s71 offen offset:1024 sc1
    s_add_u32 s77, s79, 0
    v_mfma_f32_16x16x32_bf16 v[44:47], a[196:199], v[216:219], v[44:47]
    buffer_load_dwordx2 v[10:11], v80, s[36:39], s77 offen sc1
    s_add_u32 s77, s79, 16384
    v_mfma_f32_16x16x32_bf16 v[48:51], a[200:203], v[216:219], v[48:51]
    buffer_load_dwordx2 v[12:13], v80, s[36:39], s77 offen sc1
    s_add_u32 s77, s79, 131072
    v_mfma_f32_16x16x32_bf16 v[52:55], a[204:207], v[216:219], v[52:55]
    buffer_load_dwordx2 v[14:15], v80, s[36:39], s77 offen sc1
    s_add_u32 s77, s79, 147456
    v_mfma_f32_16x16x32_bf16 v[56:59], a[208:211], v[216:219], v[56:59]
    buffer_load_dwordx2 v[16:17], v80, s[36:39], s77 offen sc1
    s_waitcnt vmcnt(22)
    s_add_u32 s77, s79, 262144
    v_mfma_f32_16x16x32_bf16 v[40:43], a[212:215], v[220:223], v[40:43]
    buffer_load_dwordx2 v[18:19], v81, s[36:39], s77 offen sc1
    v_mfma_f32_16x16x32_bf16 v[44:47], a[216:219], v[220:223], v[44:47]
    buffer_load_dwordx4 v[20:23], v82, s[36:39], s78 offen offset:0 sc1
    v_mfma_f32_16x16x32_bf16 v[48:51], a[220:223], v[220:223], v[48:51]
    buffer_load_dwordx4 v[24:27], v82, s[36:39], s78 offen offset:16 sc1
    v_mfma_f32_16x16x32_bf16 v[52:55], a[224:227], v[220:223], v[52:55]
    buffer_load_dwordx4 v[28:31], v82, s[36:39], s78 offen offset:128 sc1
    v_mfma_f32_16x16x32_bf16 v[56:59], a[228:231], v[220:223], v[56:59]
    buffer_load_dwordx4 v[32:35], v82, s[36:39], s78 offen offset:144 sc1
    s_waitcnt vmcnt(26)
    v_mfma_f32_16x16x32_bf16 v[40:43], a[232:235], v[224:227], v[40:43]
    buffer_load_dwordx4 v[36:39], v83, s[36:39], s78 offen offset:256 sc1
    v_mfma_f32_16x16x32_bf16 v[44:47], a[236:239], v[224:227], v[44:47]
    v_mfma_f32_16x16x32_bf16 v[48:51], a[240:243], v[224:227], v[48:51]
    v_mfma_f32_16x16x32_bf16 v[52:55], a[244:247], v[224:227], v[52:55]
    v_mfma_f32_16x16x32_bf16 v[56:59], a[248:251], v[224:227], v[56:59]
    s_waitcnt vmcnt(26)
    v_mfma_f32_16x16x32_bf16 v[40:43], a[252:255], v[228:231], v[40:43]
    v_mfma_f32_16x16x32_bf16 v[44:47], v[96:99], v[228:231], v[44:47]
    v_mfma_f32_16x16x32_bf16 v[48:51], v[100:103], v[228:231], v[48:51]
    v_mfma_f32_16x16x32_bf16 v[52:55], v[104:107], v[228:231], v[52:55]
    v_mfma_f32_16x16x32_bf16 v[56:59], v[108:111], v[228:231], v[56:59]
    s_waitcnt vmcnt(25)
    v_mfma_f32_16x16x32_bf16 v[40:43], v[112:115], v[152:155], v[40:43]
    v_mfma_f32_16x16x32_bf16 v[44:47], v[116:119], v[152:155], v[44:47]
    v_mfma_f32_16x16x32_bf16 v[48:51], v[120:123], v[152:155], v[48:51]
    v_mfma_f32_16x16x32_bf16 v[52:55], v[124:127], v[152:155], v[52:55]
    v_mfma_f32_16x16x32_bf16 v[56:59], v[128:131], v[152:155], v[56:59]
    s_waitcnt vmcnt(24)
    v_mfma_f32_16x16x32_bf16 v[40:43], v[132:135], v[156:159], v[40:43]
    v_mfma_f32_16x16x32_bf16 v[44:47], v[136:139], v[156:159], v[44:47]
    v_mfma_f32_16x16x32_bf16 v[48:51], v[140:143], v[156:159], v[48:51]
    v_mfma_f32_16x16x32_bf16 v[52:55], v[144:147], v[156:159], v[52:55]
    v_mfma_f32_16x16x32_bf16 v[56:59], v[148:151], v[156:159], v[56:59]
    s_waitcnt vmcnt(23)
    v_mfma_f32_16x16x32_bf16 v[60:63], a[32:35], v[160:163], 0
    v_mfma_f32_16x16x32_bf16 v[64:67], a[36:39], v[160:163], 0
    v_mfma_f32_16x16x32_bf16 v[68:71], a[40:43], v[160:163], 0
    ds_write_b128 v9, v[40:43] offset:10240
    v_mfma_f32_16x16x32_bf16 v[72:75], a[44:47], v[160:163], 0
    v_mfma_f32_16x16x32_bf16 v[76:79], a[48:51], v[160:163], 0
    s_waitcnt vmcnt(22)
    v_mfma_f32_16x16x32_bf16 v[60:63], a[52:55], v[164:167], v[60:63]
    ds_write_b128 v9, v[44:47] offset:11264
    v_mfma_f32_16x16x32_bf16 v[64:67], a[56:59], v[164:167], v[64:67]
    s_waitcnt vmcnt(9)
    v_lshlrev_b32 v80, 16, v10
    v_and_b32 v81, 0xffff0000, v10
    v_mfma_f32_16x16x32_bf16 v[68:71], a[60:63], v[164:167], v[68:71]
    v_lshlrev_b32 v82, 16, v11
    v_and_b32 v83, 0xffff0000, v11
    v_mfma_f32_16x16x32_bf16 v[72:75], a[64:67], v[164:167], v[72:75]
    ds_write_b128 v9, v[48:51] offset:12288
    v_mfma_f32_16x16x32_bf16 v[76:79], a[68:71], v[164:167], v[76:79]
    s_waitcnt vmcnt(8)
    v_lshlrev_b32 v84, 16, v12
    v_and_b32 v85, 0xffff0000, v12
    v_mfma_f32_16x16x32_bf16 v[60:63], a[72:75], v[168:171], v[60:63]
    v_lshlrev_b32 v86, 16, v13
    v_and_b32 v87, 0xffff0000, v13
    v_mfma_f32_16x16x32_bf16 v[64:67], a[76:79], v[168:171], v[64:67]
    ds_write_b128 v9, v[52:55] offset:13312
    v_mfma_f32_16x16x32_bf16 v[68:71], a[80:83], v[168:171], v[68:71]
    s_waitcnt vmcnt(7)
    v_lshlrev_b32 v88, 16, v14
    v_and_b32 v89, 0xffff0000, v14
    v_mfma_f32_16x16x32_bf16 v[72:75], a[84:87], v[168:171], v[72:75]
    v_lshlrev_b32 v90, 16, v15
    v_and_b32 v91, 0xffff0000, v15
    v_mfma_f32_16x16x32_bf16 v[76:79], a[88:91], v[168:171], v[76:79]
    ds_write_b128 v9, v[56:59] offset:14336
    v_mfma_f32_16x16x32_bf16 v[60:63], a[92:95], v[172:175], v[60:63]
    s_waitcnt vmcnt(6)
    v_lshlrev_b32 v92, 16, v16
    v_and_b32 v93, 0xffff0000, v16
    v_mfma_f32_16x16x32_bf16 v[64:67], a[96:99], v[172:175], v[64:67]
    s_waitcnt lgkmcnt(0)
    s_barrier
    v_lshlrev_b32 v94, 16, v17
    v_mfma_f32_16x16x32_bf16 v[68:71], a[100:103], v[172:175], v[68:71]
    ds_read_b128 v[232:235], v4 offset:0
    v_and_b32 v95, 0xffff0000, v17
    v_mfma_f32_16x16x32_bf16 v[72:75], a[104:107], v[172:175], v[72:75]
    ds_read_b128 v[236:239], v4 offset:1024
    s_waitcnt vmcnt(5)
    v_lshlrev_b32 v252, 16, v18
    v_mfma_f32_16x16x32_bf16 v[76:79], a[108:111], v[172:175], v[76:79]
    ds_read_b128 v[240:243], v4 offset:2048
    v_and_b32 v253, 0xffff0000, v18
    v_mfma_f32_16x16x32_bf16 v[60:63], a[112:115], v[176:179], v[60:63]
    ds_read_b128 v[244:247], v4 offset:3072
    v_lshlrev_b32 v254, 16, v19
    v_mfma_f32_16x16x32_bf16 v[64:67], a[116:119], v[176:179], v[64:67]
    ds_read_b128 v[248:251], v4 offset:4096
    v_and_b32 v255, 0xffff0000, v19
    v_mfma_f32_16x16x32_bf16 v[68:71], a[120:123], v[176:179], v[68:71]
    ds_read_b128 v[152:155], v4 offset:5120
    v_mfma_f32_16x16x32_bf16 v[72:75], a[124:127], v[176:179], v[72:75]
    ds_read_b128 v[156:159], v4 offset:6144
    v_mfma_f32_16x16x32_bf16 v[76:79], a[128:131], v[176:179], v[76:79]
    ds_read_b128 v[160:163], v4 offset:7168
    v_mfma_f32_16x16x32_bf16 v[60:63], a[132:135], v[180:183], v[60:63]
    ds_read_b128 v[164:167], v4 offset:8192
    v_mfma_f32_16x16x32_bf16 v[64:67], a[136:139], v[180:183], v[64:67]
    ds_read_b128 v[168:171], v4 offset:9216
    v_mfma_f32_16x16x32_bf16 v[68:71], a[140:143], v[180:183], v[68:71]
    ds_read_b128 v[40:43], v4 offset:10240
    v_mfma_f32_16x16x32_bf16 v[72:75], a[144:147], v[180:183], v[72:75]
    ds_read_b128 v[44:47], v4 offset:11264
    v_mfma_f32_16x16x32_bf16 v[76:79], a[148:151], v[180:183], v[76:79]
    ds_read_b128 v[48:51], v4 offset:12288
    v_mfma_f32_16x16x32_bf16 v[60:63], a[152:155], v[184:187], v[60:63]
    ds_read_b128 v[52:55], v4 offset:13312
    v_mfma_f32_16x16x32_bf16 v[64:67], a[156:159], v[184:187], v[64:67]
    ds_read_b128 v[56:59], v4 offset:14336
    s_waitcnt lgkmcnt(9)
    v_add_f32 v232, v232, v152
    v_mfma_f32_16x16x32_bf16 v[68:71], a[160:163], v[184:187], v[68:71]
    v_add_f32 v233, v233, v153
    v_add_f32 v234, v234, v154
    v_mfma_f32_16x16x32_bf16 v[72:75], a[164:167], v[184:187], v[72:75]
    v_add_f32 v235, v235, v155
    v_mfma_f32_16x16x32_bf16 v[76:79], a[168:171], v[184:187], v[76:79]
    s_waitcnt lgkmcnt(8)
    v_add_f32 v236, v236, v156
    v_add_f32 v237, v237, v157
    v_mfma_f32_16x16x32_bf16 v[60:63], a[172:175], v[188:191], v[60:63]
    v_add_f32 v238, v238, v158
    v_add_f32 v239, v239, v159
    v_mfma_f32_16x16x32_bf16 v[64:67], a[176:179], v[188:191], v[64:67]
    s_waitcnt lgkmcnt(7)
    v_add_f32 v240, v240, v160
    v_add_f32 v241, v241, v161
    v_mfma_f32_16x16x32_bf16 v[68:71], a[180:183], v[188:191], v[68:71]
    v_add_f32 v242, v242, v162
    v_add_f32 v243, v243, v163
    v_mfma_f32_16x16x32_bf16 v[72:75], a[184:187], v[188:191], v[72:75]
    s_waitcnt lgkmcnt(6)
    v_add_f32 v244, v244, v164
    v_add_f32 v245, v245, v165
    v_mfma_f32_16x16x32_bf16 v[76:79], a[188:191], v[188:191], v[76:79]
    v_add_f32 v246, v246, v166
    v_add_f32 v247, v247, v167
    v_mfma_f32_16x16x32_bf16 v[60:63], a[192:195], v[192:195], v[60:63]
    s_waitcnt lgkmcnt(5)
    v_add_f32 v248, v248, v168
    v_add_f32 v249, v249, v169
    v_mfma_f32_16x16x32_bf16 v[64:67], a[196:199], v[192:195], v[64:67]
    v_add_f32 v250, v250, v170
    v_add_f32 v251, v251, v171
    v_mfma_f32_16x16x32_bf16 v[68:71], a[200:203], v[192:195], v[68:71]
    s_waitcnt lgkmcnt(4)
    v_add_f32 v232, v232, v40
    v_add_f32 v233, v233, v41
    v_mfma_f32_16x16x32_bf16 v[72:75], a[204:207], v[192:195], v[72:75]
    v_add_f32 v234, v234, v42
    v_add_f32 v235, v235, v43
    v_mfma_f32_16x16x32_bf16 v[76:79], a[208:211], v[192:195], v[76:79]
    s_waitcnt lgkmcnt(3)
    v_add_f32 v236, v236, v44
    v_add_f32 v237, v237, v45
    v_mfma_f32_16x16x32_bf16 v[60:63], a[212:215], v[196:199], v[60:63]
    v_add_f32 v238, v238, v46
    v_add_f32 v239, v239, v47
    v_mfma_f32_16x16x32_bf16 v[64:67], a[216:219], v[196:199], v[64:67]
    s_waitcnt lgkmcnt(2)
    v_add_f32 v240, v240, v48
    v_add_f32 v241, v241, v49
    v_mfma_f32_16x16x32_bf16 v[68:71], a[220:223], v[196:199], v[68:71]
    v_add_f32 v242, v242, v50
    v_add_f32 v243, v243, v51
    v_mfma_f32_16x16x32_bf16 v[72:75], a[224:227], v[196:199], v[72:75]
    s_waitcnt lgkmcnt(1)
    v_add_f32 v244, v244, v52
    v_add_f32 v245, v245, v53
    v_mfma_f32_16x16x32_bf16 v[76:79], a[228:231], v[196:199], v[76:79]
    v_add_f32 v246, v246, v54
    v_add_f32 v247, v247, v55
    v_mfma_f32_16x16x32_bf16 v[60:63], a[232:235], v[200:203], v[60:63]
    s_waitcnt lgkmcnt(0)
    v_add_f32 v248, v248, v56
    v_add_f32 v249, v249, v57
    v_mfma_f32_16x16x32_bf16 v[64:67], a[236:239], v[200:203], v[64:67]
    v_add_f32 v250, v250, v58
    v_add_f32 v251, v251, v59
    v_mfma_f32_16x16x32_bf16 v[68:71], a[240:243], v[200:203], v[68:71]
    s_waitcnt vmcnt(4)
    v_fmac_f32 v80, v20, v232
    v_fmac_f32 v81, v21, v233
    v_mfma_f32_16x16x32_bf16 v[72:75], a[244:247], v[200:203], v[72:75]
    v_fmac_f32 v82, v22, v234
    v_fmac_f32 v83, v23, v235
    v_mfma_f32_16x16x32_bf16 v[76:79], a[248:251], v[200:203], v[76:79]
    s_waitcnt vmcnt(3)
    v_fmac_f32 v84, v24, v236
    v_fmac_f32 v85, v25, v237
    v_mfma_f32_16x16x32_bf16 v[60:63], a[252:255], v[204:207], v[60:63]
    v_fmac_f32 v86, v26, v238
    v_fmac_f32 v87, v27, v239
    v_mfma_f32_16x16x32_bf16 v[64:67], v[96:99], v[204:207], v[64:67]
    s_waitcnt vmcnt(2)
    v_fmac_f32 v88, v28, v240
    v_fmac_f32 v89, v29, v241
    v_mfma_f32_16x16x32_bf16 v[68:71], v[100:103], v[204:207], v[68:71]
    v_fmac_f32 v90, v30, v242
    v_fmac_f32 v91, v31, v243
    v_mfma_f32_16x16x32_bf16 v[72:75], v[104:107], v[204:207], v[72:75]
    s_waitcnt vmcnt(1)
    v_fmac_f32 v92, v32, v244
    v_fmac_f32 v93, v33, v245
    v_mfma_f32_16x16x32_bf16 v[76:79], v[108:111], v[204:207], v[76:79]
    v_fmac_f32 v94, v34, v246
    v_fmac_f32 v95, v35, v247
    v_mfma_f32_16x16x32_bf16 v[60:63], v[112:115], v[208:211], v[60:63]
    s_waitcnt vmcnt(0)
    v_fmac_f32 v252, v36, v248
    v_fmac_f32 v253, v37, v249
    v_mfma_f32_16x16x32_bf16 v[64:67], v[116:119], v[208:211], v[64:67]
    v_fmac_f32 v254, v38, v250
    v_fmac_f32 v255, v39, v251
    v_mfma_f32_16x16x32_bf16 v[68:71], v[120:123], v[208:211], v[68:71]
    v_mfma_f32_16x16x32_bf16 v[72:75], v[124:127], v[208:211], v[72:75]
    v_mfma_f32_16x16x32_bf16 v[76:79], v[128:131], v[208:211], v[76:79]
    v_mfma_f32_16x16x32_bf16 v[60:63], v[132:135], v[212:215], v[60:63]
    v_mfma_f32_16x16x32_bf16 v[64:67], v[136:139], v[212:215], v[64:67]
    v_mfma_f32_16x16x32_bf16 v[68:71], v[140:143], v[212:215], v[68:71]
    v_mfma_f32_16x16x32_bf16 v[72:75], v[144:147], v[212:215], v[72:75]
    v_mfma_f32_16x16x32_bf16 v[76:79], v[148:151], v[212:215], v[76:79]
    s_nop 3
    v_pk_fma_f32 v[80:81], v[20:21], v[60:61], v[80:81]
    v_cvt_pk_bf16_f32 v232, v80, v81
    v_pk_fma_f32 v[82:83], v[22:23], v[62:63], v[82:83]
    v_cvt_pk_bf16_f32 v233, v82, v83
    v_pk_fma_f32 v[84:85], v[24:25], v[64:65], v[84:85]
    v_cvt_pk_bf16_f32 v234, v84, v85
    v_pk_fma_f32 v[86:87], v[26:27], v[66:67], v[86:87]
    v_cvt_pk_bf16_f32 v235, v86, v87
    buffer_store_dwordx4 v[232:235], v5, s[40:43], s76 offen
    v_pk_fma_f32 v[88:89], v[28:29], v[68:69], v[88:89]
    v_cvt_pk_bf16_f32 v236, v88, v89
    v_pk_fma_f32 v[90:91], v[30:31], v[70:71], v[90:91]
    v_cvt_pk_bf16_f32 v237, v90, v91
    v_pk_fma_f32 v[92:93], v[32:33], v[72:73], v[92:93]
    v_cvt_pk_bf16_f32 v238, v92, v93
    v_pk_fma_f32 v[94:95], v[34:35], v[74:75], v[94:95]
    v_cvt_pk_bf16_f32 v239, v94, v95
    buffer_store_dwordx4 v[236:239], v5, s[40:43], s76 offen offset:64
    v_pk_fma_f32 v[252:253], v[36:37], v[76:77], v[252:253]
    v_cvt_pk_bf16_f32 v240, v252, v253
    v_pk_fma_f32 v[254:255], v[38:39], v[78:79], v[254:255]
    v_cvt_pk_bf16_f32 v241, v254, v255
    buffer_store_dwordx2 v[240:241], v6, s[40:43], s76 offen offset:128
F_fin:
    s_endpgm
Lx0:
    s_mov_b32 s97, 0
Lx0_l:
    s_add_u32 s65, s64, 0
    buffer_load_dwordx4 v[96:99], v7, s[36:39], s65 offen sc1
    s_add_u32 s65, s64, 16384
    buffer_load_dwordx4 v[100:103], v7, s[36:39], s65 offen sc1
    s_add_u32 s65, s64, 131072
    buffer_load_dwordx4 v[104:107], v7, s[36:39], s65 offen sc1
    s_add_u32 s65, s64, 147456
    buffer_load_dwordx4 v[108:111], v7, s[36:39], s65 offen sc1
    s_add_u32 s97, s97, 1
    s_waitcnt vmcnt(0)
    v_max3_u32 v11, v96, v100, v104
    v_max_u32 v11, v11, v108
    v_cmp_eq_u32 vcc, -1, v11
    s_nop 4
    s_cbranch_vccz Lx0_k
    s_cmp_lt_u32 s97, 0x40000
    s_cbranch_scc1 Lx0_l
Lx0_k:
    s_add_u32 s65, s64, 262144
    buffer_load_dwordx4 v[112:115], v7, s[36:39], s65 offen sc1
    s_add_u32 s65, s64, 278528
    buffer_load_dwordx4 v[116:119], v7, s[36:39], s65 offen sc1
    s_add_u32 s65, s64, 393216
    buffer_load_dwordx4 v[120:123], v7, s[36:39], s65 offen sc1
    s_add_u32 s65, s64, 409600
    buffer_load_dwordx4 v[124:127], v7, s[36:39], s65 offen sc1
    s_add_u32 s65, s64, 524288
    buffer_load_dwordx4 v[128:131], v7, s[36:39], s65 offen sc1
    s_add_u32 s65, s64, 540672
    buffer_load_dwordx4 v[132:135], v7, s[36:39], s65 offen sc1
    s_add_u32 s65, s64, 655360
    buffer_load_dwordx4 v[136:139], v7, s[36:39], s65 offen sc1
    s_add_u32 s65, s64, 671744
    buffer_load_dwordx4 v[140:143], v7, s[36:39], s65 offen sc1
    s_add_u32 s65, s64, 786432
    buffer_load_dwordx4 v[144:147], v7, s[36:39], s65 offen sc1
    s_add_u32 s65, s64, 802816
    buffer_load_dwordx4 v[148:151], v7, s[36:39], s65 offen sc1
    s_branch Lx0_b
Lx2:
    s_mov_b32 s97, 0
Lx2_l:
    s_add_u32 s65, s64, 262144
    buffer_load_dwordx4 v[112:115], v7, s[36:39], s65 offen sc1
    s_add_u32 s65, s64, 278528
    buffer_load_dwordx4 v[116:119], v7, s[36:39], s65 offen sc1
    s_add_u32 s65, s64, 393216
    buffer_load_dwordx4 v[120:123], v7, s[36:39], s65 offen sc1
    s_add_u32 s65, s64, 409600
    buffer_load_dwordx4 v[124:127], v7, s[36:39], s65 offen sc1
    s_add_u32 s97, s97, 1
    s_waitcnt vmcnt(0)
    v_max3_u32 v11, v112, v116, v120
    v_max_u32 v11, v11, v124
    v_cmp_eq_u32 vcc, -1, v11
    s_nop 4
    s_cbranch_vccz Lx2_k
    s_cmp_lt_u32 s97, 0x40000
    s_cbranch_scc1 Lx2_l
Lx2_k:
    s_add_u32 s65, s64, 524288
    buffer_load_dwordx4 v[128:131], v7, s[36:39], s65 offen sc1
    s_add_u32 s65, s64, 540672
    buffer_load_dwordx4 v[132:135], v7, s[36:39], s65 offen sc1
    s_add_u32 s65, s64, 655360
    buffer_load_dwordx4 v[136:139], v7, s[36:39], s65 offen sc1
    s_add_u32 s65, s64, 671744
    buffer_load_dwordx4 v[140:143], v7, s[36:39], s65 offen sc1
    s_add_u32 s65, s64, 786432
    buffer_load_dwordx4 v[144:147], v7, s[36:39], s65 offen sc1
    s_add_u32 s65, s64, 802816
    buffer_load_dwordx4 v[148:151], v7, s[36:39], s65 offen sc1
    s_add_u32 s65, s64, 917504
    buffer_load_dwordx4 v[152:155], v7, s[36:39], s65 offen sc1
    s_add_u32 s65, s64, 933888
    buffer_load_dwordx4 v[156:159], v7, s[36:39], s65 offen sc1
    s_add_u32 s65, s64, 1048576
    buffer_load_dwordx4 v[160:163], v7, s[36:39], s65 offen sc1
    s_add_u32 s65, s64, 1064960
    buffer_load_dwordx4 v[164:167], v7, s[36:39], s65 offen sc1
    s_branch Lx2_b
Lx4:
    s_mov_b32 s97, 0
Lx4_l:
    s_add_u32 s65, s64, 524288
    buffer_load_dwordx4 v[128:131], v7, s[36:39], s65 offen sc1
    s_add_u32 s65, s64, 540672
    buffer_load_dwordx4 v[132:135], v7, s[36:39], s65 offen sc1
    s_add_u32 s65, s64, 655360
    buffer_load_dwordx4 v[136:139], v7, s[36:39], s65 offen sc1
    s_add_u32 s65, s64, 671744
    buffer_load_dwordx4 v[140:143], v7, s[36:39], s65 offen sc1
    s_add_u32 s97, s97, 1
    s_waitcnt vmcnt(0)
    v_max3_u32 v11, v128, v132, v136
    v_max_u32 v11, v11, v140
    v_cmp_eq_u32 vcc, -1, v11
    s_nop 4
    s_cbranch_vccz Lx4_k
    s_cmp_lt_u32 s97, 0x40000
    s_cbranch_scc1 Lx4_l
Lx4_k:
    s_add_u32 s65, s64, 786432
    buffer_load_dwordx4 v[144:147], v7, s[36:39], s65 offen sc1
    s_add_u32 s65, s64, 802816
    buffer_load_dwordx4 v[148:151], v7, s[36:39], s65 offen sc1
    s_add_u32 s65, s64, 917504
    buffer_load_dwordx4 v[152:155], v7, s[36:39], s65 offen sc1
    s_add_u32 s65, s64, 933888
    buffer_load_dwordx4 v[156:159], v7, s[36:39], s65 offen sc1
    s_add_u32 s65, s64, 1048576
    buffer_load_dwordx4 v[160:163], v7, s[36:39], s65 offen sc1
    s_add_u32 s65, s64, 1064960
    buffer_load_dwordx4 v[164:167], v7, s[36:39], s65 offen sc1
    s_add_u32 s65, s64, 1179648
    buffer_load_dwordx4 v[168:171], v7, s[36:39], s65 offen sc1
    s_add_u32 s65, s64, 1196032
    buffer_load_dwordx4 v[172:175], v7, s[36:39], s65 offen sc1
    s_add_u32 s65, s64, 1310720
    buffer_load_dwordx4 v[176:179], v7, s[36:39], s65 offen sc1
    s_add_u32 s65, s64, 1327104
    buffer_load_dwordx4 v[180:183], v7, s[36:39], s65 offen sc1
    s_branch Lx4_b
Lx6:
    s_mov_b32 s97, 0
Lx6_l:
    s_add_u32 s65, s64, 786432
    buffer_load_dwordx4 v[144:147], v7, s[36:39], s65 offen sc1
    s_add_u32 s65, s64, 802816
    buffer_load_dwordx4 v[148:151], v7, s[36:39], s65 offen sc1
    s_add_u32 s65, s64, 917504
    buffer_load_dwordx4 v[152:155], v7, s[36:39], s65 offen sc1
    s_add_u32 s65, s64, 933888
    buffer_load_dwordx4 v[156:159], v7, s[36:39], s65 offen sc1
    s_add_u32 s97, s97, 1
    s_waitcnt vmcnt(0)
    v_max3_u32 v11, v144, v148, v152
    v_max_u32 v11, v11, v156
    v_cmp_eq_u32 vcc, -1, v11
    s_nop 4
    s_cbranch_vccz Lx6_k
    s_cmp_lt_u32 s97, 0x40000
    s_cbranch_scc1 Lx6_l
Lx6_k:
    s_add_u32 s65, s64, 1048576
    buffer_load_dwordx4 v[160:163], v7, s[36:39], s65 offen sc1
    s_add_u32 s65, s64, 1064960
    buffer_load_dwordx4 v[164:167], v7, s[36:39], s65 offen sc1
    s_add_u32 s65, s64, 1179648
    buffer_load_dwordx4 v[168:171], v7, s[36:39], s65 offen sc1
    s_add_u32 s65, s64, 1196032
    buffer_load_dwordx4 v[172:175], v7, s[36:39], s65 offen sc1
    s_add_u32 s65, s64, 1310720
    buffer_load_dwordx4 v[176:179], v7, s[36:39], s65 offen sc1
    s_add_u32 s65, s64, 1327104
    buffer_load_dwordx4 v[180:183], v7, s[36:39], s65 offen sc1
    s_add_u32 s65, s64, 1441792
    buffer_load_dwordx4 v[184:187], v7, s[36:39], s65 offen sc1
    s_add_u32 s65, s64, 1458176
    buffer_load_dwordx4 v[188:191], v7, s[36:39], s65 offen sc1
    s_add_u32 s65, s64, 1572864
    buffer_load_dwordx4 v[192:195], v7, s[36:39], s65 offen sc1
    s_add_u32 s65, s64, 1589248
    buffer_load_dwordx4 v[196:199], v7, s[36:39], s65 offen sc1
    s_branch Lx6_b
Lx8:
    s_mov_b32 s97, 0
Lx8_l:
    s_add_u32 s65, s64, 1048576
    buffer_load_dwordx4 v[160:163], v7, s[36:39], s65 offen sc1
    s_add_u32 s65, s64, 1064960
    buffer_load_dwordx4 v[164:167], v7, s[36:39], s65 offen sc1
    s_add_u32 s65, s64, 1179648
    buffer_load_dwordx4 v[168:171], v7, s[36:39], s65 offen sc1
    s_add_u32 s65, s64, 1196032
    buffer_load_dwordx4 v[172:175], v7, s[36:39], s65 offen sc1
    s_add_u32 s97, s97, 1
    s_waitcnt vmcnt(0)
    v_max3_u32 v11, v160, v164, v168
    v_max_u32 v11, v11, v172
    v_cmp_eq_u32 vcc, -1, v11
    s_nop 4
    s_cbranch_vccz Lx8_k
    s_cmp_lt_u32 s97, 0x40000
    s_cbranch_scc1 Lx8_l
Lx8_k:
    s_add_u32 s65, s64, 1310720
    buffer_load_dwordx4 v[176:179], v7, s[36:39], s65 offen sc1
    s_add_u32 s65, s64, 1327104
    buffer_load_dwordx4 v[180:183], v7, s[36:39], s65 offen sc1
    s_add_u32 s65, s64, 1441792
    buffer_load_dwordx4 v[184:187], v7, s[36:39], s65 offen sc1
    s_add_u32 s65, s64, 1458176
    buffer_load_dwordx4 v[188:191], v7, s[36:39], s65 offen sc1
    s_add_u32 s65, s64, 1572864
    buffer_load_dwordx4 v[192:195], v7, s[36:39], s65 offen sc1
    s_add_u32 s65, s64, 1589248
    buffer_load_dwordx4 v[196:199], v7, s[36:39], s65 offen sc1
    s_add_u32 s65, s64, 1703936
    buffer_load_dwordx4 v[200:203], v7, s[36:39], s65 offen sc1
    s_add_u32 s65, s64, 1720320
    buffer_load_dwordx4 v[204:207], v7, s[36:39], s65 offen sc1
    s_add_u32 s65, s64, 1835008
    buffer_load_dwordx4 v[208:211], v7, s[36:39], s65 offen sc1
    s_add_u32 s65, s64, 1851392
    buffer_load_dwordx4 v[212:215], v7, s[36:39], s65 offen sc1
    s_branch Lx8_b
Lx10:
    s_mov_b32 s97, 0
Lx10_l:
    s_add_u32 s65, s64, 1310720
    buffer_load_dwordx4 v[176:179], v7, s[36:39], s65 offen sc1
    s_add_u32 s65, s64, 1327104
    buffer_load_dwordx4 v[180:183], v7, s[36:39], s65 offen sc1
    s_add_u32 s65, s64, 1441792
    buffer_load_dwordx4 v[184:187], v7, s[36:39], s65 offen sc1
    s_add_u32 s65, s64, 1458176
    buffer_load_dwordx4 v[188:191], v7, s[36:39], s65 offen sc1
    s_add_u32 s97, s97, 1
    s_waitcnt vmcnt(0)
    v_max3_u32 v11, v176, v180, v184
    v_max_u32 v11, v11, v188
    v_cmp_eq_u32 vcc, -1, v11
    s_nop 4
    s_cbranch_vccz Lx10_k
    s_cmp_lt_u32 s97, 0x40000
    s_cbranch_scc1 Lx10_l
Lx10_k:
    s_add_u32 s65, s64, 1572864
    buffer_load_dwordx4 v[192:195], v7, s[36:39], s65 offen sc1
    s_add_u32 s65, s64, 1589248
    buffer_load_dwordx4 v[196:199], v7, s[36:39], s65 offen sc1
    s_add_u32 s65, s64, 1703936
    buffer_load_dwordx4 v[200:203], v7, s[36:39], s65 offen sc1
    s_add_u32 s65, s64, 1720320
    buffer_load_dwordx4 v[204:207], v7, s[36:39], s65 offen sc1
    s_add_u32 s65, s64, 1835008
    buffer_load_dwordx4 v[208:211], v7, s[36:39], s65 offen sc1
    s_add_u32 s65, s64, 1851392
    buffer_load_dwordx4 v[212:215], v7, s[36:39], s65 offen sc1
    s_add_u32 s65, s64, 1966080
    buffer_load_dwordx4 v[216:219], v7, s[36:39], s65 offen sc1
    s_add_u32 s65, s64, 1982464
    buffer_load_dwordx4 v[220:223], v7, s[36:39], s65 offen sc1
    buffer_load_dword a255, v7, s[36:39], s51 offen
    s_add_u32 s65, s64, 2097152
    buffer_load_dwordx4 v[224:227], v7, s[36:39], s65 offen sc1
    s_add_u32 s65, s64, 2113536
    buffer_load_dwordx4 v[228:231], v7, s[36:39], s65 offen sc1
    s_branch Lx10_b
Lx12:
    s_mov_b32 s97, 0
Lx12_l:
    s_add_u32 s65, s64, 1572864
    buffer_load_dwordx4 v[192:195], v7, s[36:39], s65 offen sc1
    s_add_u32 s65, s64, 1589248
    buffer_load_dwordx4 v[196:199], v7, s[36:39], s65 offen sc1
    s_add_u32 s65, s64, 1703936
    buffer_load_dwordx4 v[200:203], v7, s[36:39], s65 offen sc1
    s_add_u32 s65, s64, 1720320
    buffer_load_dwordx4 v[204:207], v7, s[36:39], s65 offen sc1
    s_add_u32 s97, s97, 1
    s_waitcnt vmcnt(0)
    v_max3_u32 v11, v192, v196, v200
    v_max_u32 v11, v11, v204
    v_cmp_eq_u32 vcc, -1, v11
    s_nop 4
    s_cbranch_vccz Lx12_k
    s_cmp_lt_u32 s97, 0x40000
    s_cbranch_scc1 Lx12_l
Lx12_k:
    s_add_u32 s65, s64, 1835008
    buffer_load_dwordx4 v[208:211], v7, s[36:39], s65 offen sc1
    s_add_u32 s65, s64, 1851392
    buffer_load_dwordx4 v[212:215], v7, s[36:39], s65 offen sc1
    s_add_u32 s65, s64, 1966080
    buffer_load_dwordx4 v[216:219], v7, s[36:39], s65 offen sc1
    s_add_u32 s65, s64, 1982464
    buffer_load_dwordx4 v[220:223], v7, s[36:39], s65 offen sc1
    buffer_load_dword a255, v7, s[36:39], s51 offen
    s_add_u32 s65, s64, 2097152
    buffer_load_dwordx4 v[224:227], v7, s[36:39], s65 offen sc1
    s_add_u32 s65, s64, 2113536
    buffer_load_dwordx4 v[228:231], v7, s[36:39], s65 offen sc1
    s_add_u32 s65, s64, 2228224
    buffer_load_dwordx4 v[232:235], v7, s[36:39], s65 offen sc1
    s_add_u32 s65, s64, 2244608
    buffer_load_dwordx4 v[236:239], v7, s[36:39], s65 offen sc1
    s_add_u32 s65, s64, 2359296
    buffer_load_dwordx4 v[240:243], v7, s[36:39], s65 offen sc1
    s_add_u32 s65, s64, 2375680
    buffer_load_dwordx4 v[244:247], v7, s[36:39], s65 offen sc1
    s_branch Lx12_b
Lx14:
    s_mov_b32 s97, 0
Lx14_l:
    s_add_u32 s65, s64, 1835008
    buffer_load_dwordx4 v[208:211], v7, s[36:39], s65 offen sc1
    s_add_u32 s65, s64, 1851392
    buffer_load_dwordx4 v[212:215], v7, s[36:39], s65 offen sc1
    s_add_u32 s65, s64, 1966080
    buffer_load_dwordx4 v[216:219], v7, s[36:39], s65 offen sc1
    s_add_u32 s65, s64, 1982464
    buffer_load_dwordx4 v[220:223], v7, s[36:39], s65 offen sc1
    s_add_u32 s97, s97, 1
    s_waitcnt vmcnt(0)
    v_max3_u32 v11, v208, v212, v216
    v_max_u32 v11, v11, v220
    v_cmp_eq_u32 vcc, -1, v11
    s_nop 4
    s_cbranch_vccz Lx14_k
    s_cmp_lt_u32 s97, 0x40000
    s_cbranch_scc1 Lx14_l
Lx14_k:
    buffer_load_dword a255, v7, s[36:39], s51 offen
    s_add_u32 s65, s64, 2097152
    buffer_load_dwordx4 v[224:227], v7, s[36:39], s65 offen sc1
    s_add_u32 s65, s64, 2113536
    buffer_load_dwordx4 v[228:231], v7, s[36:39], s65 offen sc1
    s_add_u32 s65, s64, 2228224
    buffer_load_dwordx4 v[232:235], v7, s[36:39], s65 offen sc1
    s_add_u32 s65, s64, 2244608
    buffer_load_dwordx4 v[236:239], v7, s[36:39], s65 offen sc1
    s_add_u32 s65, s64, 2359296
    buffer_load_dwordx4 v[240:243], v7, s[36:39], s65 offen sc1
    s_add_u32 s65, s64, 2375680
    buffer_load_dwordx4 v[244:247], v7, s[36:39], s65 offen sc1
    s_add_u32 s65, s64, 2490368
    buffer_load_dwordx4 v[248:251], v7, s[36:39], s65 offen sc1
    s_add_u32 s65, s64, 2506752
    buffer_load_dwordx4 v[252:255], v7, s[36:39], s65 offen sc1
    buffer_load_dword a255, v7, s[36:39], s51 offen
    s_branch Lx14_b
Lx16:
    s_mov_b32 s97, 0
Lx16_l:
    s_add_u32 s65, s64, 2097152
    buffer_load_dwordx4 v[224:227], v7, s[36:39], s65 offen sc1
    s_add_u32 s65, s64, 2113536
    buffer_load_dwordx4 v[228:231], v7, s[36:39], s65 offen sc1
    s_add_u32 s65, s64, 2228224
    buffer_load_dwordx4 v[232:235], v7, s[36:39], s65 offen sc1
    s_add_u32 s65, s64, 2244608
    buffer_load_dwordx4 v[236:239], v7, s[36:39], s65 offen sc1
    s_add_u32 s97, s97, 1
    s_waitcnt vmcnt(0)
    v_max3_u32 v11, v224, v228, v232
    v_max_u32 v11, v11, v236
    v_cmp_eq_u32 vcc, -1, v11
    s_nop 4
    s_cbranch_vccz Lx16_k
    s_cmp_lt_u32 s97, 0x40000
    s_cbranch_scc1 Lx16_l
Lx16_k:
    s_add_u32 s65, s64, 2359296
    buffer_load_dwordx4 v[240:243], v7, s[36:39], s65 offen sc1
    s_add_u32 s65, s64, 2375680
    buffer_load_dwordx4 v[244:247], v7, s[36:39], s65 offen sc1
    s_add_u32 s65, s64, 2490368
    buffer_load_dwordx4 v[248:251], v7, s[36:39], s65 offen sc1
    s_add_u32 s65, s64, 2506752
    buffer_load_dwordx4 v[252:255], v7, s[36:39], s65 offen sc1
    buffer_load_dword a255, v7, s[36:39], s51 offen
    buffer_load_dword a255, v7, s[36:39], s51 offen
    buffer_load_dword a255, v7, s[36:39], s51 offen
    buffer_load_dword a255, v7, s[36:39], s51 offen
    buffer_load_dword a255, v7, s[36:39], s51 offen
    s_branch Lx16_b
Lx18:
    s_mov_b32 s97, 0
Lx18_l:
    s_add_u32 s65, s64, 2359296
    buffer_load_dwordx4 v[240:243], v7, s[36:39], s65 offen sc1
    s_add_u32 s65, s64, 2375680
    buffer_load_dwordx4 v[244:247], v7, s[36:39], s65 offen sc1
    s_add_u32 s65, s64, 2490368
    buffer_load_dwordx4 v[248:251], v7, s[36:39], s65 offen sc1
    s_add_u32 s65, s64, 2506752
    buffer_load_dwordx4 v[252:255], v7, s[36:39], s65 offen sc1
    s_add_u32 s97, s97, 1
    s_waitcnt vmcnt(0)
    v_max3_u32 v11, v240, v244, v248
    v_max_u32 v11, v11, v252
    v_cmp_eq_u32 vcc, -1, v11
    s_nop 4
    s_cbranch_vccz Lx18_k
    s_cmp_lt_u32 s97, 0x40000
    s_cbranch_scc1 Lx18_l
Lx18_k:
    buffer_load_dword a255, v7, s[36:39], s51 offen
    buffer_load_dword a255, v7, s[36:39], s51 offen
    buffer_load_dword a255, v7, s[36:39], s51 offen
    buffer_load_dword a255, v7, s[36:39], s51 offen
    buffer_load_dword a255, v7, s[36:39], s51 offen
    buffer_load_dword a255, v7, s[36:39], s51 offen
    buffer_load_dword a255, v7, s[36:39], s51 offen
    buffer_load_dword a255, v7, s[36:39], s51 offen
    s_branch Lx18_b
F_end:
    s_endpgm
.section .rodata,"a"
.p2align 6
.amdhsa_kernel adaLN_cond__ssm_conv_s4d__dense_activation_silu__prompt_kernel
  .amdhsa_next_free_vgpr 512
  .amdhsa_next_free_sgpr 102
  .amdhsa_accum_offset 256
  .amdhsa_group_segment_fixed_size 0
  .amdhsa_kernarg_size 120
  .amdhsa_user_sgpr_count 2
  .amdhsa_user_sgpr_kernarg_segment_ptr 1
  .amdhsa_system_sgpr_workgroup_id_x 1
.end_amdhsa_kernel
```
